```python
import torch

def _softmax(x, axis=-1):
    return torch.softmax(x, dim=axis)
def _gelu(x):
    return torch.nn.functional.gelu(x, approximate="tanh")
def _silu(x):
    return torch.nn.functional.silu(x)
def _sigmoid(x):
    return torch.sigmoid(x)
def _layernorm(x, axis=-1, eps=1e-5):
    m = x.mean(dim=axis, keepdim=True)
    v = x.var(dim=axis, keepdim=True, unbiased=False)
    return (x - m) / torch.sqrt(v + eps)
def _scatter_add(tgt, idx, src, axis=0):
    return tgt.clone().index_add_(axis, idx, src)
def _segment_sum(src, seg, n):
    out = torch.zeros((n,) + src.shape[1:], dtype=src.dtype)
    return out.index_add_(0, seg, src)
def _pad(x, pw):
    flat = tuple(v for pair in reversed(pw) for v in pair)
    return torch.nn.functional.pad(x, flat)

kernel_name = 'gated_mix__grouped_kv_mqa__linear_attn_block__prompt'

def setup_inputs():

    _w = (lambda a: (lambda t: t.to(torch.bfloat16) if t.is_floating_point() else t)(torch.as_tensor(a)))
    def _A_setup():
        B, S, D, H = 1, 2048, 576, 32
        Dh = D // H
        return {
            "x": _w((lambda *s: torch.randn(*s, dtype=torch.bfloat16) * 0.05)(B, S, D)),
            "wq": _w((lambda *s: torch.randn(*s, dtype=torch.bfloat16) * 1.6)(D, H * Dh)),
            "wk": _w((lambda *s: torch.randn(*s, dtype=torch.bfloat16) * 1.6)(D, Dh)),
            "wv": _w((lambda *s: torch.randn(*s, dtype=torch.bfloat16) * 0.05)(D, Dh)),
            "wo": _w((lambda *s: torch.randn(*s, dtype=torch.bfloat16) * 0.05)(H * Dh, D)),
        }
    _A_in = _A_setup()

    def _B_setup():
        B, S, D = 1, 2048, 576
        return {
            "x": _w((lambda *s: torch.randn(*s, dtype=torch.bfloat16) * 0.05)(B, S, D)),
            "wqkv": _w((lambda *s: torch.randn(*s, dtype=torch.bfloat16) * 1.6)(D, 3 * D)),
            "wo": _w((lambda *s: torch.randn(*s, dtype=torch.bfloat16) * 0.05)(D, D)),
        }
    _B_in = _B_setup()

    return {
        "A_x": _A_in["x"],
        "A_wq": _A_in["wq"],
        "A_wk": _A_in["wk"],
        "A_wv": _A_in["wv"],
        "A_wo": _A_in["wo"],
        "B_x": _B_in["x"],
        "B_wqkv": _B_in["wqkv"],
        "B_wo": _B_in["wo"],
        "gate_w": _w((lambda *s: torch.randn(*s, dtype=torch.bfloat16) * 0.05)(576) * 16.0),
    }

def reference(A_x, A_wq, A_wk, A_wv, A_wo, B_x, B_wqkv, B_wo, gate_w):
    def _A_ref(x, wq, wk, wv, wo):
        B, S, D = x.shape
        H = 32
        Dh = D // H
        q = (lambda x, *d: x.permute(*d))((x @ wq).reshape(B, S, H, Dh), 0, 2, 1, 3)
        k = x @ wk
        v = x @ wv
        scores = torch.einsum("bhqd,bkd->bhqk", q, k) * (Dh ** -0.5)
        p = _softmax(scores, axis=-1)
        o = torch.einsum("bhqk,bkd->bhqd", p, v)
        return (lambda x, *d: x.permute(*d))(o, 0, 2, 1, 3).reshape(B, S, H * Dh) @ wo

    def _B_ref(x, wqkv, wo):
        B, S, D = x.shape
        H = 32; Dh = D // H
        qkv = (lambda x, *d: x.permute(*d))((x @ wqkv).reshape(B, S, 3, H, Dh), 2, 0, 3, 1, 4)
        q, k, v = qkv[0], qkv[1], qkv[2]
        phi = lambda t: torch.where(t > 0, t + 1, torch.exp(t)) + 1e-6
        pq, pk = phi(q), phi(k)
        kv = torch.einsum("bhsd,bhse->bhde", pk, v)
        z = torch.einsum("bhsd->bhd", pk)
        num = torch.einsum("bhqd,bhde->bhqe", pq, kv)
        den = torch.einsum("bhqd,bhd->bhq", pq, z)[..., None] + 1e-6
        o = num / den
        return (lambda x, *d: x.permute(*d))(o, 0, 2, 1, 3).reshape(B, S, D) @ wo

    x = A_x
    g = _sigmoid((x * gate_w).sum(-1, keepdims=True))
    a = _A_ref(x, A_wq, A_wk, A_wv, A_wo)
    b = _B_ref(x, B_wqkv, B_wo)
    return g * a + (1 - g) * b
```

```asm
; @launch grid=(256,1,1) block=(512,1,1) lds=163840
.amdgcn_target "amdgcn-amd-amdhsa--gfx950"
.text
.globl gated_mix__grouped_kv_mqa__linear_attn_block__prompt_kernel
.p2align 8
.type gated_mix__grouped_kv_mqa__linear_attn_block__prompt_kernel,@function
gated_mix__grouped_kv_mqa__linear_attn_block__prompt_kernel:
    s_cmp_ge_u32 s2, 256
    s_cbranch_scc1 attn_kernel_end
    s_load_dwordx4 s[4:7], s[0:1], 0
    s_load_dwordx4 s[8:11], s[0:1], 16
    s_load_dwordx2 s[52:53], s[0:1], 48
    s_load_dwordx2 s[54:55], s[0:1], 64
    s_load_dwordx2 s[56:57], s[0:1], 88
    s_load_dwordx2 s[58:59], s[0:1], 32
    s_load_dwordx2 s[60:61], s[0:1], 56
    s_load_dwordx2 s[96:97], s[0:1], 72
    s_and_b32 s42, s2, 7
    s_lshr_b32 s43, s2, 3
    s_and_b32 s44, s42, 1
    s_lshl_b32 s44, s44, 3
    s_and_b32 s45, s43, 7
    s_add_u32 s12, s44, s45
    s_lshr_b32 s44, s42, 1
    s_lshl_b32 s44, s44, 2
    s_lshr_b32 s46, s43, 3
    s_add_u32 s13, s44, s46
    s_lshl_b32 s46, s46, 1
    s_add_u32 s16, s45, s46
    s_cmp_ge_u32 s16, 9
    s_cselect_b32 s46, 9, 0
    s_sub_u32 s16, s16, s46
    v_lshrrev_b32 v176, 6, v0
    v_and_b32 v0, 63, v0
    v_readfirstlane_b32 s14, v176
    v_and_b32 v1, 31, v0
    v_lshrrev_b32 v2, 5, v0
    s_nop 0
    s_and_b32 s15, s14, 3
    s_lshl_b32 s41, s15, 10
    s_mov_b32 s100, 0
    s_mov_b32 s101, 0
    v_lshrrev_b32 v183, 3, v0
    s_lshl_b32 s42, s12, 7
    s_lshl_b32 s43, s15, 3
    s_add_u32 s42, s42, s43
    v_add_u32 v183, s42, v183
    v_mul_u32_u24 v183, 1152, v183
    s_and_b32 s42, s15, 1
    s_lshl_b32 s42, s42, 2
    v_lshrrev_b32 v184, 4, v0
    v_add_u32 v184, s42, v184
    v_and_b32 v184, 7, v184
    v_and_b32 v185, 7, v0
    v_xor_b32 v184, v184, v185
    v_lshlrev_b32 v184, 4, v184
    v_add_u32 v3, v183, v184
    s_waitcnt lgkmcnt(0)
    s_mov_b32 s20, s4
    s_and_b32 s21, s5, 0xffff
    s_mov_b32 s22, 2359296
    s_mov_b32 s23, 0x20000
    s_cmp_ge_u32 s13, 8
    s_cselect_b32 s50, 1, 0
    s_cmp_lt_u32 s13, 4
    s_cselect_b32 s42, s6, s52
    s_cselect_b32 s43, s7, s53
    s_mov_b32 s49, 3456
    s_cmov_b32 s49, 1152
    s_mov_b32 s44, 1990656
    s_cmov_b32 s44, 663552
    s_mov_b32 s24, s42
    s_and_b32 s25, s43, 0xffff
    s_mov_b32 s26, s44
    s_mov_b32 s27, 0x20000
    s_and_b32 s42, s13, 3
    s_mul_i32 s42, s42, 288
    s_sub_u32 s43, s13, 8
    s_mul_i32 s43, s43, 144
    s_add_u32 s43, s43, 1152
    s_cmp_eq_u32 s50, 0
    s_cselect_b32 s48, s42, s43
    s_lshl_b32 s36, s49, 6
    s_cmp_ge_u32 s14, 4
    s_cbranch_scc1 proj_bsetup
    s_mov_b32 s17, s16
    s_lshl_b32 s38, s17, 7
    s_add_u32 m0, s41, 0
    s_add_u32 s42, s38, 0
    buffer_load_dwordx4 v3, s[20:23], s42 offen lds
    s_add_u32 m0, s41, 4096
    s_add_u32 s42, s38, 36864
    buffer_load_dwordx4 v3, s[20:23], s42 offen lds
    s_add_u32 m0, s41, 8192
    s_add_u32 s42, s38, 73728
    buffer_load_dwordx4 v3, s[20:23], s42 offen lds
    s_add_u32 m0, s41, 12288
    s_add_u32 s42, s38, 110592
    buffer_load_dwordx4 v3, s[20:23], s42 offen lds
    s_mov_b32 s32, s56
    s_and_b32 s33, s57, 0xffff
    s_mov_b32 s34, 16777216
    s_mov_b32 s35, 0x20000
    v_lshrrev_b32 v176, 1, v1
    v_and_b32 v176, 7, v176
    v_xor_b32 v176, v176, v2
    v_lshlrev_b32 v176, 4, v176
    v_lshlrev_b32 v177, 7, v1
    v_add_u32 v176, v176, v177
    s_and_b32 s42, s14, 1
    s_lshl_b32 s42, s42, 13
    v_add_u32 v148, s42, v176
    v_xor_b32 v149, 32, v148
    v_xor_b32 v150, 64, v148
    v_xor_b32 v151, 96, v148
    v_lshrrev_b32 v178, 4, v0
    v_and_b32 v178, 1, v178
    v_lshrrev_b32 v179, 2, v0
    v_and_b32 v179, 3, v179
    v_and_b32 v180, 3, v0
    v_lshlrev_b32 v181, 3, v2
    v_add_u32 v181, v181, v179
    v_add_u32 v182, v178, v179
    v_lshlrev_b32 v182, 1, v182
    v_lshrrev_b32 v183, 1, v180
    v_add_u32 v182, v182, v183
    v_mul_u32_u24 v183, 288, v181
    v_and_b32 v184, 1, v180
    v_lshlrev_b32 v184, 3, v184
    v_add_u32 v183, v183, v184
    v_add_u32 v183, 65536, v183
    s_lshr_b32 s42, s14, 1
    s_lshl_b32 s42, s42, 2
    s_add_u32 s43, s42, 0
    v_add_u32 v184, s43, v182
    v_and_b32 v184, 15, v184
    v_lshlrev_b32 v184, 4, v184
    v_add_u32 v152, v183, v184
    v_add_u32 v156, 61440, v152
    s_add_u32 s43, s42, 8
    v_add_u32 v184, s43, v182
    v_and_b32 v184, 15, v184
    v_lshlrev_b32 v184, 4, v184
    v_add_u32 v153, v183, v184
    v_add_u32 v157, 61440, v153
    s_add_u32 s43, s42, 8
    v_add_u32 v184, s43, v182
    v_and_b32 v184, 15, v184
    v_lshlrev_b32 v184, 4, v184
    v_add_u32 v154, v183, v184
    v_add_u32 v158, 61440, v154
    s_add_u32 s43, s42, 16
    v_add_u32 v184, s43, v182
    v_and_b32 v184, 15, v184
    v_lshlrev_b32 v184, 4, v184
    v_add_u32 v155, v183, v184
    v_add_u32 v159, 61440, v155
    v_cmp_eq_u32 vcc, 0, v178
    v_mov_b32 v183, 32
    v_mov_b32 v184, 288
    v_cndmask_b32 v183, v183, v184, vcc
    v_mov_b32 v184, 83968
    v_mov_b32 v185, 65792
    v_cndmask_b32 v184, v184, v185, vcc
    v_lshlrev_b32 v185, 3, v180
    v_add_u32 v184, v184, v185
    v_mul_lo_u32 v185, v181, v183
    v_add_u32 v184, v184, v185
    v_lshlrev_b32 v183, 2, v183
    v_mad_u32_u24 v160, v183, 0, v184
    v_add_u32 v168, 61440, v160
    v_mad_u32_u24 v161, v183, 1, v184
    v_add_u32 v169, 61440, v161
    v_mad_u32_u24 v162, v183, 4, v184
    v_add_u32 v170, 61440, v162
    v_mad_u32_u24 v163, v183, 5, v184
    v_add_u32 v171, 61440, v163
    v_mad_u32_u24 v164, v183, 8, v184
    v_add_u32 v172, 61440, v164
    v_mad_u32_u24 v165, v183, 9, v184
    v_add_u32 v173, 61440, v165
    v_mad_u32_u24 v166, v183, 12, v184
    v_add_u32 v174, 61440, v166
    v_mad_u32_u24 v167, v183, 13, v184
    v_add_u32 v175, 61440, v167
    v_mov_b32 v194, 163824
    v_mov_b32 v195, 0
    ds_write_b32 v194, v195
    ds_write_b32 v194, v195 offset:4
    ds_write_b32 v194, v195 offset:8
    ds_write_b32 v194, v195 offset:12
    s_load_dwordx2 s[42:43], s[0:1], 80
    v_mov_b32 v195, 0
    s_waitcnt lgkmcnt(0)
    s_mov_b32 s28, s42
    s_and_b32 s29, s43, 0xffff
    s_mov_b32 s30, 256
    s_mov_b32 s31, 0x20000
    v_mov_b32 v68, 0
    v_mov_b32 v69, 0
    v_mov_b32 v70, 0
    v_mov_b32 v71, 0
    v_mov_b32 v72, 0
    v_mov_b32 v73, 0
    v_mov_b32 v74, 0
    v_mov_b32 v75, 0
    v_mov_b32 v76, 0
    v_mov_b32 v77, 0
    v_mov_b32 v78, 0
    v_mov_b32 v79, 0
    v_mov_b32 v80, 0
    v_mov_b32 v81, 0
    v_mov_b32 v82, 0
    v_mov_b32 v83, 0
    v_mov_b32 v84, 0
    v_mov_b32 v85, 0
    v_mov_b32 v86, 0
    v_mov_b32 v87, 0
    v_mov_b32 v88, 0
    v_mov_b32 v89, 0
    v_mov_b32 v90, 0
    v_mov_b32 v91, 0
    v_mov_b32 v92, 0
    v_mov_b32 v93, 0
    v_mov_b32 v94, 0
    v_mov_b32 v95, 0
    v_mov_b32 v96, 0
    v_mov_b32 v97, 0
    v_mov_b32 v98, 0
    v_mov_b32 v99, 0
    v_mov_b32 v100, 0
    v_mov_b32 v101, 0
    v_mov_b32 v102, 0
    v_mov_b32 v103, 0
    v_mov_b32 v104, 0
    v_mov_b32 v105, 0
    v_mov_b32 v106, 0
    v_mov_b32 v107, 0
    v_mov_b32 v108, 0
    v_mov_b32 v109, 0
    v_mov_b32 v110, 0
    v_mov_b32 v111, 0
    v_mov_b32 v112, 0
    v_mov_b32 v113, 0
    v_mov_b32 v114, 0
    v_mov_b32 v115, 0
    v_mov_b32 v116, 0
    v_mov_b32 v117, 0
    v_mov_b32 v118, 0
    v_mov_b32 v119, 0
    v_mov_b32 v120, 0
    v_mov_b32 v121, 0
    v_mov_b32 v122, 0
    v_mov_b32 v123, 0
    v_mov_b32 v124, 0
    v_mov_b32 v125, 0
    v_mov_b32 v126, 0
    v_mov_b32 v127, 0
    v_mov_b32 v128, 0
    v_mov_b32 v129, 0
    v_mov_b32 v130, 0
    v_mov_b32 v131, 0
    v_mov_b32 v132, 0
    v_mov_b32 v133, 0
    v_mov_b32 v134, 0
    v_mov_b32 v135, 0
    v_mov_b32 v136, 0
    v_mov_b32 v137, 0
    v_mov_b32 v138, 0
    v_mov_b32 v139, 0
    v_mov_b32 v140, 0
    v_mov_b32 v141, 0
    v_mov_b32 v142, 0
    v_mov_b32 v143, 0
    v_mov_b32 v144, 0
    v_mov_b32 v145, 0
    v_mov_b32 v146, 0
    v_mov_b32 v147, 0
    s_lshr_b32 s47, s14, 1
    s_cmp_eq_u32 s50, 0
    s_cbranch_scc0 proj_a_kv
    s_cmp_eq_u32 s47, 0
    s_cbranch_scc0 proj_a_q1
    s_waitcnt vmcnt(0)
    s_barrier
    ds_read_b128 v[8:11], v148 offset:0
    ds_read_b128 v[12:15], v148 offset:4096
    ds_read_b64_tr_b16 v[32:33], v152 offset:0
    ds_read_b64_tr_b16 v[34:35], v153 offset:1152
    ds_read_b64_tr_b16 v[36:37], v154 offset:0
    ds_read_b64_tr_b16 v[38:39], v155 offset:1152
    ds_read_b64_tr_b16 v[40:41], v160 offset:0
    ds_read_b64_tr_b16 v[42:43], v161 offset:0
    ds_read_b128 v[16:19], v149 offset:0
    ds_read_b128 v[20:23], v149 offset:4096
    ds_read_b64_tr_b16 v[44:45], v152 offset:4608
    ds_read_b64_tr_b16 v[46:47], v153 offset:5760
    ds_read_b64_tr_b16 v[48:49], v154 offset:4608
    ds_read_b64_tr_b16 v[50:51], v155 offset:5760
    ds_read_b64_tr_b16 v[52:53], v162 offset:0
    ds_read_b64_tr_b16 v[54:55], v163 offset:0
    s_waitcnt lgkmcnt(8)
    v_mfma_f32_32x32x16_bf16 v[68:83], v[32:35], v[8:11], v[68:83]
    ds_read_b128 v[24:27], v150 offset:0
    ds_read_b128 v[28:31], v150 offset:4096
    v_mfma_f32_32x32x16_bf16 v[84:99], v[36:39], v[8:11], v[84:99]
    ds_read_b64_tr_b16 v[56:57], v152 offset:9216
    ds_read_b64_tr_b16 v[58:59], v153 offset:10368
    v_mfma_f32_32x32x16_bf16 v[100:115], v[32:35], v[12:15], v[100:115]
    ds_read_b64_tr_b16 v[60:61], v154 offset:9216
    ds_read_b64_tr_b16 v[62:63], v155 offset:10368
    v_mfma_f32_32x32x16_bf16 v[116:131], v[36:39], v[12:15], v[116:131]
    ds_read_b64_tr_b16 v[64:65], v164 offset:0
    ds_read_b64_tr_b16 v[66:67], v165 offset:0
    v_mfma_f32_32x32x16_bf16 v[132:147], v[40:43], v[8:11], v[132:147]
    s_waitcnt lgkmcnt(8)
    v_mfma_f32_32x32x16_bf16 v[68:83], v[44:47], v[16:19], v[68:83]
    ds_read_b128 v[8:11], v151 offset:0
    ds_read_b128 v[12:15], v151 offset:4096
    v_mfma_f32_32x32x16_bf16 v[84:99], v[48:51], v[16:19], v[84:99]
    ds_read_b64_tr_b16 v[32:33], v152 offset:13824
    ds_read_b64_tr_b16 v[34:35], v153 offset:14976
    v_mfma_f32_32x32x16_bf16 v[100:115], v[44:47], v[20:23], v[100:115]
    ds_read_b64_tr_b16 v[36:37], v154 offset:13824
    ds_read_b64_tr_b16 v[38:39], v155 offset:14976
    v_mfma_f32_32x32x16_bf16 v[116:131], v[48:51], v[20:23], v[116:131]
    ds_read_b64_tr_b16 v[40:41], v166 offset:0
    ds_read_b64_tr_b16 v[42:43], v167 offset:0
    v_mfma_f32_32x32x16_bf16 v[132:147], v[52:55], v[16:19], v[132:147]
    s_waitcnt lgkmcnt(0)
    s_barrier
    v_mfma_f32_32x32x16_bf16 v[68:83], v[56:59], v[24:27], v[68:83]
    ds_read_b128 v[16:19], v148 offset:16384
    ds_read_b128 v[20:23], v148 offset:20480
    v_mfma_f32_32x32x16_bf16 v[84:99], v[60:63], v[24:27], v[84:99]
    ds_read_b64_tr_b16 v[44:45], v152 offset:20480
    ds_read_b64_tr_b16 v[46:47], v153 offset:21632
    v_mfma_f32_32x32x16_bf16 v[100:115], v[56:59], v[28:31], v[100:115]
    ds_read_b64_tr_b16 v[48:49], v154 offset:20480
    ds_read_b64_tr_b16 v[50:51], v155 offset:21632
    v_mfma_f32_32x32x16_bf16 v[116:131], v[60:63], v[28:31], v[116:131]
    ds_read_b64_tr_b16 v[52:53], v160 offset:20480
    ds_read_b64_tr_b16 v[54:55], v161 offset:20480
    v_mfma_f32_32x32x16_bf16 v[132:147], v[64:67], v[24:27], v[132:147]
    v_mfma_f32_32x32x16_bf16 v[68:83], v[32:35], v[8:11], v[68:83]
    ds_read_b128 v[24:27], v149 offset:16384
    ds_read_b128 v[28:31], v149 offset:20480
    v_mfma_f32_32x32x16_bf16 v[84:99], v[36:39], v[8:11], v[84:99]
    ds_read_b64_tr_b16 v[56:57], v152 offset:25088
    ds_read_b64_tr_b16 v[58:59], v153 offset:26240
    v_mfma_f32_32x32x16_bf16 v[100:115], v[32:35], v[12:15], v[100:115]
    ds_read_b64_tr_b16 v[60:61], v154 offset:25088
    ds_read_b64_tr_b16 v[62:63], v155 offset:26240
    v_mfma_f32_32x32x16_bf16 v[116:131], v[36:39], v[12:15], v[116:131]
    ds_read_b64_tr_b16 v[64:65], v162 offset:20480
    ds_read_b64_tr_b16 v[66:67], v163 offset:20480
    v_mfma_f32_32x32x16_bf16 v[132:147], v[40:43], v[8:11], v[132:147]
    s_waitcnt lgkmcnt(8)
    v_mfma_f32_32x32x16_bf16 v[68:83], v[44:47], v[16:19], v[68:83]
    ds_read_b128 v[8:11], v150 offset:16384
    ds_read_b128 v[12:15], v150 offset:20480
    v_mfma_f32_32x32x16_bf16 v[84:99], v[48:51], v[16:19], v[84:99]
    ds_read_b64_tr_b16 v[32:33], v152 offset:29696
    ds_read_b64_tr_b16 v[34:35], v153 offset:30848
    v_mfma_f32_32x32x16_bf16 v[100:115], v[44:47], v[20:23], v[100:115]
    ds_read_b64_tr_b16 v[36:37], v154 offset:29696
    ds_read_b64_tr_b16 v[38:39], v155 offset:30848
    v_mfma_f32_32x32x16_bf16 v[116:131], v[48:51], v[20:23], v[116:131]
    ds_read_b64_tr_b16 v[40:41], v164 offset:20480
    ds_read_b64_tr_b16 v[42:43], v165 offset:20480
    v_mfma_f32_32x32x16_bf16 v[132:147], v[52:55], v[16:19], v[132:147]
    s_waitcnt lgkmcnt(8)
    v_mfma_f32_32x32x16_bf16 v[68:83], v[56:59], v[24:27], v[68:83]
    ds_read_b128 v[16:19], v151 offset:16384
    ds_read_b128 v[20:23], v151 offset:20480
    v_mfma_f32_32x32x16_bf16 v[84:99], v[60:63], v[24:27], v[84:99]
    ds_read_b64_tr_b16 v[44:45], v152 offset:34304
    ds_read_b64_tr_b16 v[46:47], v153 offset:35456
    v_mfma_f32_32x32x16_bf16 v[100:115], v[56:59], v[28:31], v[100:115]
    ds_read_b64_tr_b16 v[48:49], v154 offset:34304
    ds_read_b64_tr_b16 v[50:51], v155 offset:35456
    v_mfma_f32_32x32x16_bf16 v[116:131], v[60:63], v[28:31], v[116:131]
    ds_read_b64_tr_b16 v[52:53], v166 offset:20480
    ds_read_b64_tr_b16 v[54:55], v167 offset:20480
    v_mfma_f32_32x32x16_bf16 v[132:147], v[64:67], v[24:27], v[132:147]
    s_waitcnt lgkmcnt(0)
    s_barrier
    v_mfma_f32_32x32x16_bf16 v[68:83], v[32:35], v[8:11], v[68:83]
    ds_read_b128 v[24:27], v148 offset:32768
    ds_read_b128 v[28:31], v148 offset:36864
    v_mfma_f32_32x32x16_bf16 v[84:99], v[36:39], v[8:11], v[84:99]
    ds_read_b64_tr_b16 v[56:57], v152 offset:40960
    ds_read_b64_tr_b16 v[58:59], v153 offset:42112
    v_mfma_f32_32x32x16_bf16 v[100:115], v[32:35], v[12:15], v[100:115]
    ds_read_b64_tr_b16 v[60:61], v154 offset:40960
    ds_read_b64_tr_b16 v[62:63], v155 offset:42112
    v_mfma_f32_32x32x16_bf16 v[116:131], v[36:39], v[12:15], v[116:131]
    ds_read_b64_tr_b16 v[64:65], v160 offset:40960
    ds_read_b64_tr_b16 v[66:67], v161 offset:40960
    v_mfma_f32_32x32x16_bf16 v[132:147], v[40:43], v[8:11], v[132:147]
    v_mfma_f32_32x32x16_bf16 v[68:83], v[44:47], v[16:19], v[68:83]
    ds_read_b128 v[8:11], v149 offset:32768
    ds_read_b128 v[12:15], v149 offset:36864
    v_mfma_f32_32x32x16_bf16 v[84:99], v[48:51], v[16:19], v[84:99]
    ds_read_b64_tr_b16 v[32:33], v152 offset:45568
    ds_read_b64_tr_b16 v[34:35], v153 offset:46720
    v_mfma_f32_32x32x16_bf16 v[100:115], v[44:47], v[20:23], v[100:115]
    ds_read_b64_tr_b16 v[36:37], v154 offset:45568
    ds_read_b64_tr_b16 v[38:39], v155 offset:46720
    v_mfma_f32_32x32x16_bf16 v[116:131], v[48:51], v[20:23], v[116:131]
    ds_read_b64_tr_b16 v[40:41], v162 offset:40960
    ds_read_b64_tr_b16 v[42:43], v163 offset:40960
    v_mfma_f32_32x32x16_bf16 v[132:147], v[52:55], v[16:19], v[132:147]
    s_waitcnt lgkmcnt(8)
    v_mfma_f32_32x32x16_bf16 v[68:83], v[56:59], v[24:27], v[68:83]
    ds_read_b128 v[16:19], v150 offset:32768
    ds_read_b128 v[20:23], v150 offset:36864
    v_mfma_f32_32x32x16_bf16 v[84:99], v[60:63], v[24:27], v[84:99]
    ds_read_b64_tr_b16 v[44:45], v152 offset:50176
    ds_read_b64_tr_b16 v[46:47], v153 offset:51328
    v_mfma_f32_32x32x16_bf16 v[100:115], v[56:59], v[28:31], v[100:115]
    ds_read_b64_tr_b16 v[48:49], v154 offset:50176
    ds_read_b64_tr_b16 v[50:51], v155 offset:51328
    v_mfma_f32_32x32x16_bf16 v[116:131], v[60:63], v[28:31], v[116:131]
    ds_read_b64_tr_b16 v[52:53], v164 offset:40960
    ds_read_b64_tr_b16 v[54:55], v165 offset:40960
    v_mfma_f32_32x32x16_bf16 v[132:147], v[64:67], v[24:27], v[132:147]
    s_waitcnt lgkmcnt(8)
    v_mfma_f32_32x32x16_bf16 v[68:83], v[32:35], v[8:11], v[68:83]
    ds_read_b128 v[24:27], v151 offset:32768
    ds_read_b128 v[28:31], v151 offset:36864
    v_mfma_f32_32x32x16_bf16 v[84:99], v[36:39], v[8:11], v[84:99]
    ds_read_b64_tr_b16 v[56:57], v152 offset:54784
    ds_read_b64_tr_b16 v[58:59], v153 offset:55936
    v_mfma_f32_32x32x16_bf16 v[100:115], v[32:35], v[12:15], v[100:115]
    ds_read_b64_tr_b16 v[60:61], v154 offset:54784
    ds_read_b64_tr_b16 v[62:63], v155 offset:55936
    v_mfma_f32_32x32x16_bf16 v[116:131], v[36:39], v[12:15], v[116:131]
    ds_read_b64_tr_b16 v[64:65], v166 offset:40960
    ds_read_b64_tr_b16 v[66:67], v167 offset:40960
    v_mfma_f32_32x32x16_bf16 v[132:147], v[40:43], v[8:11], v[132:147]
    s_waitcnt lgkmcnt(0)
    s_barrier
    v_mfma_f32_32x32x16_bf16 v[68:83], v[44:47], v[16:19], v[68:83]
    ds_read_b128 v[8:11], v148 offset:49152
    ds_read_b128 v[12:15], v148 offset:53248
    v_mfma_f32_32x32x16_bf16 v[84:99], v[48:51], v[16:19], v[84:99]
    ds_read_b64_tr_b16 v[32:33], v156 offset:0
    ds_read_b64_tr_b16 v[34:35], v157 offset:1152
    v_mfma_f32_32x32x16_bf16 v[100:115], v[44:47], v[20:23], v[100:115]
    ds_read_b64_tr_b16 v[36:37], v158 offset:0
    ds_read_b64_tr_b16 v[38:39], v159 offset:1152
    v_mfma_f32_32x32x16_bf16 v[116:131], v[48:51], v[20:23], v[116:131]
    ds_read_b64_tr_b16 v[40:41], v168 offset:0
    ds_read_b64_tr_b16 v[42:43], v169 offset:0
    v_mfma_f32_32x32x16_bf16 v[132:147], v[52:55], v[16:19], v[132:147]
    v_mfma_f32_32x32x16_bf16 v[68:83], v[56:59], v[24:27], v[68:83]
    ds_read_b128 v[16:19], v149 offset:49152
    ds_read_b128 v[20:23], v149 offset:53248
    v_mfma_f32_32x32x16_bf16 v[84:99], v[60:63], v[24:27], v[84:99]
    ds_read_b64_tr_b16 v[44:45], v156 offset:4608
    ds_read_b64_tr_b16 v[46:47], v157 offset:5760
    v_mfma_f32_32x32x16_bf16 v[100:115], v[56:59], v[28:31], v[100:115]
    ds_read_b64_tr_b16 v[48:49], v158 offset:4608
    ds_read_b64_tr_b16 v[50:51], v159 offset:5760
    v_mfma_f32_32x32x16_bf16 v[116:131], v[60:63], v[28:31], v[116:131]
    ds_read_b64_tr_b16 v[52:53], v170 offset:0
    ds_read_b64_tr_b16 v[54:55], v171 offset:0
    v_mfma_f32_32x32x16_bf16 v[132:147], v[64:67], v[24:27], v[132:147]
    s_waitcnt lgkmcnt(8)
    v_mfma_f32_32x32x16_bf16 v[68:83], v[32:35], v[8:11], v[68:83]
    ds_read_b128 v[24:27], v150 offset:49152
    ds_read_b128 v[28:31], v150 offset:53248
    v_mfma_f32_32x32x16_bf16 v[84:99], v[36:39], v[8:11], v[84:99]
    ds_read_b64_tr_b16 v[56:57], v156 offset:9216
    ds_read_b64_tr_b16 v[58:59], v157 offset:10368
    v_mfma_f32_32x32x16_bf16 v[100:115], v[32:35], v[12:15], v[100:115]
    ds_read_b64_tr_b16 v[60:61], v158 offset:9216
    ds_read_b64_tr_b16 v[62:63], v159 offset:10368
    v_mfma_f32_32x32x16_bf16 v[116:131], v[36:39], v[12:15], v[116:131]
    ds_read_b64_tr_b16 v[64:65], v172 offset:0
    ds_read_b64_tr_b16 v[66:67], v173 offset:0
    v_mfma_f32_32x32x16_bf16 v[132:147], v[40:43], v[8:11], v[132:147]
    s_waitcnt lgkmcnt(8)
    v_mfma_f32_32x32x16_bf16 v[68:83], v[44:47], v[16:19], v[68:83]
    ds_read_b128 v[8:11], v151 offset:49152
    ds_read_b128 v[12:15], v151 offset:53248
    v_mfma_f32_32x32x16_bf16 v[84:99], v[48:51], v[16:19], v[84:99]
    ds_read_b64_tr_b16 v[32:33], v156 offset:13824
    ds_read_b64_tr_b16 v[34:35], v157 offset:14976
    v_mfma_f32_32x32x16_bf16 v[100:115], v[44:47], v[20:23], v[100:115]
    ds_read_b64_tr_b16 v[36:37], v158 offset:13824
    ds_read_b64_tr_b16 v[38:39], v159 offset:14976
    v_mfma_f32_32x32x16_bf16 v[116:131], v[48:51], v[20:23], v[116:131]
    ds_read_b64_tr_b16 v[40:41], v174 offset:0
    ds_read_b64_tr_b16 v[42:43], v175 offset:0
    v_mfma_f32_32x32x16_bf16 v[132:147], v[52:55], v[16:19], v[132:147]
    s_waitcnt lgkmcnt(0)
    s_barrier
    v_mfma_f32_32x32x16_bf16 v[68:83], v[56:59], v[24:27], v[68:83]
    ds_read_b128 v[16:19], v148 offset:0
    ds_read_b128 v[20:23], v148 offset:4096
    v_mfma_f32_32x32x16_bf16 v[84:99], v[60:63], v[24:27], v[84:99]
    ds_read_b64_tr_b16 v[44:45], v152 offset:0
    ds_read_b64_tr_b16 v[46:47], v153 offset:1152
    v_mfma_f32_32x32x16_bf16 v[100:115], v[56:59], v[28:31], v[100:115]
    ds_read_b64_tr_b16 v[48:49], v154 offset:0
    ds_read_b64_tr_b16 v[50:51], v155 offset:1152
    v_mfma_f32_32x32x16_bf16 v[116:131], v[60:63], v[28:31], v[116:131]
    ds_read_b64_tr_b16 v[52:53], v160 offset:0
    ds_read_b64_tr_b16 v[54:55], v161 offset:0
    v_mfma_f32_32x32x16_bf16 v[132:147], v[64:67], v[24:27], v[132:147]
    v_mfma_f32_32x32x16_bf16 v[68:83], v[32:35], v[8:11], v[68:83]
    ds_read_b128 v[24:27], v149 offset:0
    ds_read_b128 v[28:31], v149 offset:4096
    v_mfma_f32_32x32x16_bf16 v[84:99], v[36:39], v[8:11], v[84:99]
    ds_read_b64_tr_b16 v[56:57], v152 offset:4608
    ds_read_b64_tr_b16 v[58:59], v153 offset:5760
    v_mfma_f32_32x32x16_bf16 v[100:115], v[32:35], v[12:15], v[100:115]
    ds_read_b64_tr_b16 v[60:61], v154 offset:4608
    ds_read_b64_tr_b16 v[62:63], v155 offset:5760
    v_mfma_f32_32x32x16_bf16 v[116:131], v[36:39], v[12:15], v[116:131]
    ds_read_b64_tr_b16 v[64:65], v162 offset:0
    ds_read_b64_tr_b16 v[66:67], v163 offset:0
    v_mfma_f32_32x32x16_bf16 v[132:147], v[40:43], v[8:11], v[132:147]
    s_waitcnt lgkmcnt(8)
    v_mfma_f32_32x32x16_bf16 v[68:83], v[44:47], v[16:19], v[68:83]
    ds_read_b128 v[8:11], v150 offset:0
    ds_read_b128 v[12:15], v150 offset:4096
    v_mfma_f32_32x32x16_bf16 v[84:99], v[48:51], v[16:19], v[84:99]
    ds_read_b64_tr_b16 v[32:33], v152 offset:9216
    ds_read_b64_tr_b16 v[34:35], v153 offset:10368
    v_mfma_f32_32x32x16_bf16 v[100:115], v[44:47], v[20:23], v[100:115]
    ds_read_b64_tr_b16 v[36:37], v154 offset:9216
    ds_read_b64_tr_b16 v[38:39], v155 offset:10368
    v_mfma_f32_32x32x16_bf16 v[116:131], v[48:51], v[20:23], v[116:131]
    ds_read_b64_tr_b16 v[40:41], v164 offset:0
    ds_read_b64_tr_b16 v[42:43], v165 offset:0
    v_mfma_f32_32x32x16_bf16 v[132:147], v[52:55], v[16:19], v[132:147]
    s_waitcnt lgkmcnt(8)
    v_mfma_f32_32x32x16_bf16 v[68:83], v[56:59], v[24:27], v[68:83]
    ds_read_b128 v[16:19], v151 offset:0
    ds_read_b128 v[20:23], v151 offset:4096
    v_mfma_f32_32x32x16_bf16 v[84:99], v[60:63], v[24:27], v[84:99]
    ds_read_b64_tr_b16 v[44:45], v152 offset:13824
    ds_read_b64_tr_b16 v[46:47], v153 offset:14976
    v_mfma_f32_32x32x16_bf16 v[100:115], v[56:59], v[28:31], v[100:115]
    ds_read_b64_tr_b16 v[48:49], v154 offset:13824
    ds_read_b64_tr_b16 v[50:51], v155 offset:14976
    v_mfma_f32_32x32x16_bf16 v[116:131], v[60:63], v[28:31], v[116:131]
    ds_read_b64_tr_b16 v[52:53], v166 offset:0
    ds_read_b64_tr_b16 v[54:55], v167 offset:0
    v_mfma_f32_32x32x16_bf16 v[132:147], v[64:67], v[24:27], v[132:147]
    s_waitcnt lgkmcnt(0)
    s_barrier
    v_mfma_f32_32x32x16_bf16 v[68:83], v[32:35], v[8:11], v[68:83]
    ds_read_b128 v[24:27], v148 offset:16384
    ds_read_b128 v[28:31], v148 offset:20480
    v_mfma_f32_32x32x16_bf16 v[84:99], v[36:39], v[8:11], v[84:99]
    ds_read_b64_tr_b16 v[56:57], v152 offset:20480
    ds_read_b64_tr_b16 v[58:59], v153 offset:21632
    v_mfma_f32_32x32x16_bf16 v[100:115], v[32:35], v[12:15], v[100:115]
    ds_read_b64_tr_b16 v[60:61], v154 offset:20480
    ds_read_b64_tr_b16 v[62:63], v155 offset:21632
    v_mfma_f32_32x32x16_bf16 v[116:131], v[36:39], v[12:15], v[116:131]
    ds_read_b64_tr_b16 v[64:65], v160 offset:20480
    ds_read_b64_tr_b16 v[66:67], v161 offset:20480
    v_mfma_f32_32x32x16_bf16 v[132:147], v[40:43], v[8:11], v[132:147]
    v_mfma_f32_32x32x16_bf16 v[68:83], v[44:47], v[16:19], v[68:83]
    ds_read_b128 v[8:11], v149 offset:16384
    ds_read_b128 v[12:15], v149 offset:20480
    v_mfma_f32_32x32x16_bf16 v[84:99], v[48:51], v[16:19], v[84:99]
    ds_read_b64_tr_b16 v[32:33], v152 offset:25088
    ds_read_b64_tr_b16 v[34:35], v153 offset:26240
    v_mfma_f32_32x32x16_bf16 v[100:115], v[44:47], v[20:23], v[100:115]
    ds_read_b64_tr_b16 v[36:37], v154 offset:25088
    ds_read_b64_tr_b16 v[38:39], v155 offset:26240
    v_mfma_f32_32x32x16_bf16 v[116:131], v[48:51], v[20:23], v[116:131]
    ds_read_b64_tr_b16 v[40:41], v162 offset:20480
    ds_read_b64_tr_b16 v[42:43], v163 offset:20480
    v_mfma_f32_32x32x16_bf16 v[132:147], v[52:55], v[16:19], v[132:147]
    s_waitcnt lgkmcnt(8)
    v_mfma_f32_32x32x16_bf16 v[68:83], v[56:59], v[24:27], v[68:83]
    ds_read_b128 v[16:19], v150 offset:16384
    ds_read_b128 v[20:23], v150 offset:20480
    v_mfma_f32_32x32x16_bf16 v[84:99], v[60:63], v[24:27], v[84:99]
    ds_read_b64_tr_b16 v[44:45], v152 offset:29696
    ds_read_b64_tr_b16 v[46:47], v153 offset:30848
    v_mfma_f32_32x32x16_bf16 v[100:115], v[56:59], v[28:31], v[100:115]
    ds_read_b64_tr_b16 v[48:49], v154 offset:29696
    ds_read_b64_tr_b16 v[50:51], v155 offset:30848
    v_mfma_f32_32x32x16_bf16 v[116:131], v[60:63], v[28:31], v[116:131]
    ds_read_b64_tr_b16 v[52:53], v164 offset:20480
    ds_read_b64_tr_b16 v[54:55], v165 offset:20480
    v_mfma_f32_32x32x16_bf16 v[132:147], v[64:67], v[24:27], v[132:147]
    s_waitcnt lgkmcnt(8)
    v_mfma_f32_32x32x16_bf16 v[68:83], v[32:35], v[8:11], v[68:83]
    ds_read_b128 v[24:27], v151 offset:16384
    ds_read_b128 v[28:31], v151 offset:20480
    v_mfma_f32_32x32x16_bf16 v[84:99], v[36:39], v[8:11], v[84:99]
    ds_read_b64_tr_b16 v[56:57], v152 offset:34304
    ds_read_b64_tr_b16 v[58:59], v153 offset:35456
    v_mfma_f32_32x32x16_bf16 v[100:115], v[32:35], v[12:15], v[100:115]
    ds_read_b64_tr_b16 v[60:61], v154 offset:34304
    ds_read_b64_tr_b16 v[62:63], v155 offset:35456
    v_mfma_f32_32x32x16_bf16 v[116:131], v[36:39], v[12:15], v[116:131]
    ds_read_b64_tr_b16 v[64:65], v166 offset:20480
    ds_read_b64_tr_b16 v[66:67], v167 offset:20480
    v_mfma_f32_32x32x16_bf16 v[132:147], v[40:43], v[8:11], v[132:147]
    s_waitcnt lgkmcnt(0)
    s_barrier
    v_mfma_f32_32x32x16_bf16 v[68:83], v[44:47], v[16:19], v[68:83]
    ds_read_b128 v[8:11], v148 offset:32768
    ds_read_b128 v[12:15], v148 offset:36864
    v_mfma_f32_32x32x16_bf16 v[84:99], v[48:51], v[16:19], v[84:99]
    ds_read_b64_tr_b16 v[32:33], v152 offset:40960
    ds_read_b64_tr_b16 v[34:35], v153 offset:42112
    v_mfma_f32_32x32x16_bf16 v[100:115], v[44:47], v[20:23], v[100:115]
    ds_read_b64_tr_b16 v[36:37], v154 offset:40960
    ds_read_b64_tr_b16 v[38:39], v155 offset:42112
    v_mfma_f32_32x32x16_bf16 v[116:131], v[48:51], v[20:23], v[116:131]
    ds_read_b64_tr_b16 v[40:41], v160 offset:40960
    ds_read_b64_tr_b16 v[42:43], v161 offset:40960
    v_mfma_f32_32x32x16_bf16 v[132:147], v[52:55], v[16:19], v[132:147]
    v_mfma_f32_32x32x16_bf16 v[68:83], v[56:59], v[24:27], v[68:83]
    ds_read_b128 v[16:19], v149 offset:32768
    ds_read_b128 v[20:23], v149 offset:36864
    v_mfma_f32_32x32x16_bf16 v[84:99], v[60:63], v[24:27], v[84:99]
    ds_read_b64_tr_b16 v[44:45], v152 offset:45568
    ds_read_b64_tr_b16 v[46:47], v153 offset:46720
    v_mfma_f32_32x32x16_bf16 v[100:115], v[56:59], v[28:31], v[100:115]
    ds_read_b64_tr_b16 v[48:49], v154 offset:45568
    ds_read_b64_tr_b16 v[50:51], v155 offset:46720
    v_mfma_f32_32x32x16_bf16 v[116:131], v[60:63], v[28:31], v[116:131]
    ds_read_b64_tr_b16 v[52:53], v162 offset:40960
    ds_read_b64_tr_b16 v[54:55], v163 offset:40960
    v_mfma_f32_32x32x16_bf16 v[132:147], v[64:67], v[24:27], v[132:147]
    s_waitcnt lgkmcnt(8)
    buffer_load_dword v194, v195, s[28:31], 0 offen sc1
    v_mfma_f32_32x32x16_bf16 v[68:83], v[32:35], v[8:11], v[68:83]
    ds_read_b128 v[24:27], v150 offset:32768
    ds_read_b128 v[28:31], v150 offset:36864
    v_mfma_f32_32x32x16_bf16 v[84:99], v[36:39], v[8:11], v[84:99]
    ds_read_b64_tr_b16 v[56:57], v152 offset:50176
    ds_read_b64_tr_b16 v[58:59], v153 offset:51328
    v_mfma_f32_32x32x16_bf16 v[100:115], v[32:35], v[12:15], v[100:115]
    ds_read_b64_tr_b16 v[60:61], v154 offset:50176
    ds_read_b64_tr_b16 v[62:63], v155 offset:51328
    v_mfma_f32_32x32x16_bf16 v[116:131], v[36:39], v[12:15], v[116:131]
    ds_read_b64_tr_b16 v[64:65], v164 offset:40960
    ds_read_b64_tr_b16 v[66:67], v165 offset:40960
    v_mfma_f32_32x32x16_bf16 v[132:147], v[40:43], v[8:11], v[132:147]
    s_waitcnt lgkmcnt(8)
    v_mfma_f32_32x32x16_bf16 v[68:83], v[44:47], v[16:19], v[68:83]
    ds_read_b128 v[8:11], v151 offset:32768
    ds_read_b128 v[12:15], v151 offset:36864
    v_mfma_f32_32x32x16_bf16 v[84:99], v[48:51], v[16:19], v[84:99]
    ds_read_b64_tr_b16 v[32:33], v152 offset:54784
    ds_read_b64_tr_b16 v[34:35], v153 offset:55936
    v_mfma_f32_32x32x16_bf16 v[100:115], v[44:47], v[20:23], v[100:115]
    ds_read_b64_tr_b16 v[36:37], v154 offset:54784
    ds_read_b64_tr_b16 v[38:39], v155 offset:55936
    v_mfma_f32_32x32x16_bf16 v[116:131], v[48:51], v[20:23], v[116:131]
    ds_read_b64_tr_b16 v[40:41], v166 offset:40960
    ds_read_b64_tr_b16 v[42:43], v167 offset:40960
    v_mfma_f32_32x32x16_bf16 v[132:147], v[52:55], v[16:19], v[132:147]
    s_waitcnt lgkmcnt(0)
    s_barrier
    v_mfma_f32_32x32x16_bf16 v[68:83], v[56:59], v[24:27], v[68:83]
    ds_read_b128 v[16:19], v148 offset:49152
    ds_read_b128 v[20:23], v148 offset:53248
    v_mfma_f32_32x32x16_bf16 v[84:99], v[60:63], v[24:27], v[84:99]
    ds_read_b64_tr_b16 v[44:45], v156 offset:0
    ds_read_b64_tr_b16 v[46:47], v157 offset:1152
    v_mfma_f32_32x32x16_bf16 v[100:115], v[56:59], v[28:31], v[100:115]
    ds_read_b64_tr_b16 v[48:49], v158 offset:0
    ds_read_b64_tr_b16 v[50:51], v159 offset:1152
    v_mfma_f32_32x32x16_bf16 v[116:131], v[60:63], v[28:31], v[116:131]
    ds_read_b64_tr_b16 v[52:53], v168 offset:0
    ds_read_b64_tr_b16 v[54:55], v169 offset:0
    v_mfma_f32_32x32x16_bf16 v[132:147], v[64:67], v[24:27], v[132:147]
    v_mfma_f32_32x32x16_bf16 v[68:83], v[32:35], v[8:11], v[68:83]
    ds_read_b128 v[24:27], v149 offset:49152
    ds_read_b128 v[28:31], v149 offset:53248
    v_mfma_f32_32x32x16_bf16 v[84:99], v[36:39], v[8:11], v[84:99]
    ds_read_b64_tr_b16 v[56:57], v156 offset:4608
    ds_read_b64_tr_b16 v[58:59], v157 offset:5760
    v_mfma_f32_32x32x16_bf16 v[100:115], v[32:35], v[12:15], v[100:115]
    ds_read_b64_tr_b16 v[60:61], v158 offset:4608
    ds_read_b64_tr_b16 v[62:63], v159 offset:5760
    v_mfma_f32_32x32x16_bf16 v[116:131], v[36:39], v[12:15], v[116:131]
    ds_read_b64_tr_b16 v[64:65], v170 offset:0
    ds_read_b64_tr_b16 v[66:67], v171 offset:0
    v_mfma_f32_32x32x16_bf16 v[132:147], v[40:43], v[8:11], v[132:147]
    s_waitcnt lgkmcnt(8)
    v_mfma_f32_32x32x16_bf16 v[68:83], v[44:47], v[16:19], v[68:83]
    ds_read_b128 v[8:11], v150 offset:49152
    ds_read_b128 v[12:15], v150 offset:53248
    v_mfma_f32_32x32x16_bf16 v[84:99], v[48:51], v[16:19], v[84:99]
    ds_read_b64_tr_b16 v[32:33], v156 offset:9216
    ds_read_b64_tr_b16 v[34:35], v157 offset:10368
    v_mfma_f32_32x32x16_bf16 v[100:115], v[44:47], v[20:23], v[100:115]
    ds_read_b64_tr_b16 v[36:37], v158 offset:9216
    ds_read_b64_tr_b16 v[38:39], v159 offset:10368
    v_mfma_f32_32x32x16_bf16 v[116:131], v[48:51], v[20:23], v[116:131]
    ds_read_b64_tr_b16 v[40:41], v172 offset:0
    ds_read_b64_tr_b16 v[42:43], v173 offset:0
    v_mfma_f32_32x32x16_bf16 v[132:147], v[52:55], v[16:19], v[132:147]
    s_waitcnt lgkmcnt(8)
    v_mfma_f32_32x32x16_bf16 v[68:83], v[56:59], v[24:27], v[68:83]
    ds_read_b128 v[16:19], v151 offset:49152
    ds_read_b128 v[20:23], v151 offset:53248
    v_mfma_f32_32x32x16_bf16 v[84:99], v[60:63], v[24:27], v[84:99]
    ds_read_b64_tr_b16 v[44:45], v156 offset:13824
    ds_read_b64_tr_b16 v[46:47], v157 offset:14976
    v_mfma_f32_32x32x16_bf16 v[100:115], v[56:59], v[28:31], v[100:115]
    ds_read_b64_tr_b16 v[48:49], v158 offset:13824
    ds_read_b64_tr_b16 v[50:51], v159 offset:14976
    v_mfma_f32_32x32x16_bf16 v[116:131], v[60:63], v[28:31], v[116:131]
    ds_read_b64_tr_b16 v[52:53], v174 offset:0
    ds_read_b64_tr_b16 v[54:55], v175 offset:0
    v_mfma_f32_32x32x16_bf16 v[132:147], v[64:67], v[24:27], v[132:147]
    s_waitcnt lgkmcnt(0)
    s_barrier
    v_mfma_f32_32x32x16_bf16 v[68:83], v[32:35], v[8:11], v[68:83]
    ds_read_b128 v[24:27], v148 offset:0
    ds_read_b128 v[28:31], v148 offset:4096
    v_mfma_f32_32x32x16_bf16 v[84:99], v[36:39], v[8:11], v[84:99]
    ds_read_b64_tr_b16 v[56:57], v152 offset:0
    ds_read_b64_tr_b16 v[58:59], v153 offset:1152
    v_mfma_f32_32x32x16_bf16 v[100:115], v[32:35], v[12:15], v[100:115]
    ds_read_b64_tr_b16 v[60:61], v154 offset:0
    ds_read_b64_tr_b16 v[62:63], v155 offset:1152
    v_mfma_f32_32x32x16_bf16 v[116:131], v[36:39], v[12:15], v[116:131]
    ds_read_b64_tr_b16 v[64:65], v160 offset:0
    ds_read_b64_tr_b16 v[66:67], v161 offset:0
    v_mfma_f32_32x32x16_bf16 v[132:147], v[40:43], v[8:11], v[132:147]
    v_mfma_f32_32x32x16_bf16 v[68:83], v[44:47], v[16:19], v[68:83]
    ds_read_b128 v[8:11], v149 offset:0
    ds_read_b128 v[12:15], v149 offset:4096
    v_mfma_f32_32x32x16_bf16 v[84:99], v[48:51], v[16:19], v[84:99]
    ds_read_b64_tr_b16 v[32:33], v152 offset:4608
    ds_read_b64_tr_b16 v[34:35], v153 offset:5760
    v_mfma_f32_32x32x16_bf16 v[100:115], v[44:47], v[20:23], v[100:115]
    ds_read_b64_tr_b16 v[36:37], v154 offset:4608
    ds_read_b64_tr_b16 v[38:39], v155 offset:5760
    v_mfma_f32_32x32x16_bf16 v[116:131], v[48:51], v[20:23], v[116:131]
    ds_read_b64_tr_b16 v[40:41], v162 offset:0
    ds_read_b64_tr_b16 v[42:43], v163 offset:0
    v_mfma_f32_32x32x16_bf16 v[132:147], v[52:55], v[16:19], v[132:147]
    s_waitcnt lgkmcnt(8)
    v_mfma_f32_32x32x16_bf16 v[68:83], v[56:59], v[24:27], v[68:83]
    ds_read_b128 v[16:19], v150 offset:0
    ds_read_b128 v[20:23], v150 offset:4096
    v_mfma_f32_32x32x16_bf16 v[84:99], v[60:63], v[24:27], v[84:99]
    ds_read_b64_tr_b16 v[44:45], v152 offset:9216
    ds_read_b64_tr_b16 v[46:47], v153 offset:10368
    v_mfma_f32_32x32x16_bf16 v[100:115], v[56:59], v[28:31], v[100:115]
    ds_read_b64_tr_b16 v[48:49], v154 offset:9216
    ds_read_b64_tr_b16 v[50:51], v155 offset:10368
    v_mfma_f32_32x32x16_bf16 v[116:131], v[60:63], v[28:31], v[116:131]
    ds_read_b64_tr_b16 v[52:53], v164 offset:0
    ds_read_b64_tr_b16 v[54:55], v165 offset:0
    v_mfma_f32_32x32x16_bf16 v[132:147], v[64:67], v[24:27], v[132:147]
    s_waitcnt lgkmcnt(8)
    v_mfma_f32_32x32x16_bf16 v[68:83], v[32:35], v[8:11], v[68:83]
    ds_read_b128 v[24:27], v151 offset:0
    ds_read_b128 v[28:31], v151 offset:4096
    v_mfma_f32_32x32x16_bf16 v[84:99], v[36:39], v[8:11], v[84:99]
    ds_read_b64_tr_b16 v[56:57], v152 offset:13824
    ds_read_b64_tr_b16 v[58:59], v153 offset:14976
    v_mfma_f32_32x32x16_bf16 v[100:115], v[32:35], v[12:15], v[100:115]
    ds_read_b64_tr_b16 v[60:61], v154 offset:13824
    ds_read_b64_tr_b16 v[62:63], v155 offset:14976
    v_mfma_f32_32x32x16_bf16 v[116:131], v[36:39], v[12:15], v[116:131]
    ds_read_b64_tr_b16 v[64:65], v166 offset:0
    ds_read_b64_tr_b16 v[66:67], v167 offset:0
    v_mfma_f32_32x32x16_bf16 v[132:147], v[40:43], v[8:11], v[132:147]
    s_waitcnt lgkmcnt(0)
    s_barrier
    v_mfma_f32_32x32x16_bf16 v[68:83], v[44:47], v[16:19], v[68:83]
    v_mfma_f32_32x32x16_bf16 v[84:99], v[48:51], v[16:19], v[84:99]
    v_mfma_f32_32x32x16_bf16 v[100:115], v[44:47], v[20:23], v[100:115]
    v_mfma_f32_32x32x16_bf16 v[116:131], v[48:51], v[20:23], v[116:131]
    v_mfma_f32_32x32x16_bf16 v[132:147], v[52:55], v[16:19], v[132:147]
    v_mfma_f32_32x32x16_bf16 v[68:83], v[56:59], v[24:27], v[68:83]
    v_mfma_f32_32x32x16_bf16 v[84:99], v[60:63], v[24:27], v[84:99]
    v_mfma_f32_32x32x16_bf16 v[100:115], v[56:59], v[28:31], v[100:115]
    v_mfma_f32_32x32x16_bf16 v[116:131], v[60:63], v[28:31], v[116:131]
    v_mfma_f32_32x32x16_bf16 v[132:147], v[64:67], v[24:27], v[132:147]
    s_branch proj_a_qepi
proj_a_q1:
    s_waitcnt vmcnt(0)
    s_barrier
    ds_read_b128 v[8:11], v148 offset:0
    ds_read_b128 v[12:15], v148 offset:4096
    ds_read_b64_tr_b16 v[32:33], v152 offset:0
    ds_read_b64_tr_b16 v[34:35], v153 offset:1152
    ds_read_b64_tr_b16 v[36:37], v154 offset:0
    ds_read_b64_tr_b16 v[38:39], v155 offset:1152
    ds_read_b64_tr_b16 v[40:41], v160 offset:0
    ds_read_b64_tr_b16 v[42:43], v161 offset:0
    ds_read_b128 v[16:19], v149 offset:0
    ds_read_b128 v[20:23], v149 offset:4096
    ds_read_b64_tr_b16 v[44:45], v152 offset:4608
    ds_read_b64_tr_b16 v[46:47], v153 offset:5760
    ds_read_b64_tr_b16 v[48:49], v154 offset:4608
    ds_read_b64_tr_b16 v[50:51], v155 offset:5760
    ds_read_b64_tr_b16 v[52:53], v162 offset:0
    ds_read_b64_tr_b16 v[54:55], v163 offset:0
    s_waitcnt lgkmcnt(8)
    v_mfma_f32_32x32x16_bf16 v[68:83], v[32:35], v[8:11], v[68:83]
    ds_read_b128 v[24:27], v150 offset:0
    ds_read_b128 v[28:31], v150 offset:4096
    v_mfma_f32_32x32x16_bf16 v[84:99], v[36:39], v[8:11], v[84:99]
    ds_read_b64_tr_b16 v[56:57], v152 offset:9216
    ds_read_b64_tr_b16 v[58:59], v153 offset:10368
    v_mfma_f32_32x32x16_bf16 v[100:115], v[32:35], v[12:15], v[100:115]
    ds_read_b64_tr_b16 v[60:61], v154 offset:9216
    ds_read_b64_tr_b16 v[62:63], v155 offset:10368
    v_mfma_f32_32x32x16_bf16 v[116:131], v[36:39], v[12:15], v[116:131]
    ds_read_b64_tr_b16 v[64:65], v164 offset:0
    ds_read_b64_tr_b16 v[66:67], v165 offset:0
    v_mfma_f32_32x32x16_bf16 v[132:147], v[40:43], v[12:15], v[132:147]
    s_waitcnt lgkmcnt(8)
    v_mfma_f32_32x32x16_bf16 v[68:83], v[44:47], v[16:19], v[68:83]
    ds_read_b128 v[8:11], v151 offset:0
    ds_read_b128 v[12:15], v151 offset:4096
    v_mfma_f32_32x32x16_bf16 v[84:99], v[48:51], v[16:19], v[84:99]
    ds_read_b64_tr_b16 v[32:33], v152 offset:13824
    ds_read_b64_tr_b16 v[34:35], v153 offset:14976
    v_mfma_f32_32x32x16_bf16 v[100:115], v[44:47], v[20:23], v[100:115]
    ds_read_b64_tr_b16 v[36:37], v154 offset:13824
    ds_read_b64_tr_b16 v[38:39], v155 offset:14976
    v_mfma_f32_32x32x16_bf16 v[116:131], v[48:51], v[20:23], v[116:131]
    ds_read_b64_tr_b16 v[40:41], v166 offset:0
    ds_read_b64_tr_b16 v[42:43], v167 offset:0
    v_mfma_f32_32x32x16_bf16 v[132:147], v[52:55], v[20:23], v[132:147]
    s_waitcnt lgkmcnt(0)
    s_barrier
    v_mfma_f32_32x32x16_bf16 v[68:83], v[56:59], v[24:27], v[68:83]
    ds_read_b128 v[16:19], v148 offset:16384
    ds_read_b128 v[20:23], v148 offset:20480
    v_mfma_f32_32x32x16_bf16 v[84:99], v[60:63], v[24:27], v[84:99]
    ds_read_b64_tr_b16 v[44:45], v152 offset:20480
    ds_read_b64_tr_b16 v[46:47], v153 offset:21632
    v_mfma_f32_32x32x16_bf16 v[100:115], v[56:59], v[28:31], v[100:115]
    ds_read_b64_tr_b16 v[48:49], v154 offset:20480
    ds_read_b64_tr_b16 v[50:51], v155 offset:21632
    v_mfma_f32_32x32x16_bf16 v[116:131], v[60:63], v[28:31], v[116:131]
    ds_read_b64_tr_b16 v[52:53], v160 offset:20480
    ds_read_b64_tr_b16 v[54:55], v161 offset:20480
    v_mfma_f32_32x32x16_bf16 v[132:147], v[64:67], v[28:31], v[132:147]
    v_mfma_f32_32x32x16_bf16 v[68:83], v[32:35], v[8:11], v[68:83]
    ds_read_b128 v[24:27], v149 offset:16384
    ds_read_b128 v[28:31], v149 offset:20480
    v_mfma_f32_32x32x16_bf16 v[84:99], v[36:39], v[8:11], v[84:99]
    ds_read_b64_tr_b16 v[56:57], v152 offset:25088
    ds_read_b64_tr_b16 v[58:59], v153 offset:26240
    v_mfma_f32_32x32x16_bf16 v[100:115], v[32:35], v[12:15], v[100:115]
    ds_read_b64_tr_b16 v[60:61], v154 offset:25088
    ds_read_b64_tr_b16 v[62:63], v155 offset:26240
    v_mfma_f32_32x32x16_bf16 v[116:131], v[36:39], v[12:15], v[116:131]
    ds_read_b64_tr_b16 v[64:65], v162 offset:20480
    ds_read_b64_tr_b16 v[66:67], v163 offset:20480
    v_mfma_f32_32x32x16_bf16 v[132:147], v[40:43], v[12:15], v[132:147]
    s_waitcnt lgkmcnt(8)
    v_mfma_f32_32x32x16_bf16 v[68:83], v[44:47], v[16:19], v[68:83]
    ds_read_b128 v[8:11], v150 offset:16384
    ds_read_b128 v[12:15], v150 offset:20480
    v_mfma_f32_32x32x16_bf16 v[84:99], v[48:51], v[16:19], v[84:99]
    ds_read_b64_tr_b16 v[32:33], v152 offset:29696
    ds_read_b64_tr_b16 v[34:35], v153 offset:30848
    v_mfma_f32_32x32x16_bf16 v[100:115], v[44:47], v[20:23], v[100:115]
    ds_read_b64_tr_b16 v[36:37], v154 offset:29696
    ds_read_b64_tr_b16 v[38:39], v155 offset:30848
    v_mfma_f32_32x32x16_bf16 v[116:131], v[48:51], v[20:23], v[116:131]
    ds_read_b64_tr_b16 v[40:41], v164 offset:20480
    ds_read_b64_tr_b16 v[42:43], v165 offset:20480
    v_mfma_f32_32x32x16_bf16 v[132:147], v[52:55], v[20:23], v[132:147]
    s_waitcnt lgkmcnt(8)
    v_mfma_f32_32x32x16_bf16 v[68:83], v[56:59], v[24:27], v[68:83]
    ds_read_b128 v[16:19], v151 offset:16384
    ds_read_b128 v[20:23], v151 offset:20480
    v_mfma_f32_32x32x16_bf16 v[84:99], v[60:63], v[24:27], v[84:99]
    ds_read_b64_tr_b16 v[44:45], v152 offset:34304
    ds_read_b64_tr_b16 v[46:47], v153 offset:35456
    v_mfma_f32_32x32x16_bf16 v[100:115], v[56:59], v[28:31], v[100:115]
    ds_read_b64_tr_b16 v[48:49], v154 offset:34304
    ds_read_b64_tr_b16 v[50:51], v155 offset:35456
    v_mfma_f32_32x32x16_bf16 v[116:131], v[60:63], v[28:31], v[116:131]
    ds_read_b64_tr_b16 v[52:53], v166 offset:20480
    ds_read_b64_tr_b16 v[54:55], v167 offset:20480
    v_mfma_f32_32x32x16_bf16 v[132:147], v[64:67], v[28:31], v[132:147]
    s_waitcnt lgkmcnt(0)
    s_barrier
    v_mfma_f32_32x32x16_bf16 v[68:83], v[32:35], v[8:11], v[68:83]
    ds_read_b128 v[24:27], v148 offset:32768
    ds_read_b128 v[28:31], v148 offset:36864
    v_mfma_f32_32x32x16_bf16 v[84:99], v[36:39], v[8:11], v[84:99]
    ds_read_b64_tr_b16 v[56:57], v152 offset:40960
    ds_read_b64_tr_b16 v[58:59], v153 offset:42112
    v_mfma_f32_32x32x16_bf16 v[100:115], v[32:35], v[12:15], v[100:115]
    ds_read_b64_tr_b16 v[60:61], v154 offset:40960
    ds_read_b64_tr_b16 v[62:63], v155 offset:42112
    v_mfma_f32_32x32x16_bf16 v[116:131], v[36:39], v[12:15], v[116:131]
    ds_read_b64_tr_b16 v[64:65], v160 offset:40960
    ds_read_b64_tr_b16 v[66:67], v161 offset:40960
    v_mfma_f32_32x32x16_bf16 v[132:147], v[40:43], v[12:15], v[132:147]
    v_mfma_f32_32x32x16_bf16 v[68:83], v[44:47], v[16:19], v[68:83]
    ds_read_b128 v[8:11], v149 offset:32768
    ds_read_b128 v[12:15], v149 offset:36864
    v_mfma_f32_32x32x16_bf16 v[84:99], v[48:51], v[16:19], v[84:99]
    ds_read_b64_tr_b16 v[32:33], v152 offset:45568
    ds_read_b64_tr_b16 v[34:35], v153 offset:46720
    v_mfma_f32_32x32x16_bf16 v[100:115], v[44:47], v[20:23], v[100:115]
    ds_read_b64_tr_b16 v[36:37], v154 offset:45568
    ds_read_b64_tr_b16 v[38:39], v155 offset:46720
    v_mfma_f32_32x32x16_bf16 v[116:131], v[48:51], v[20:23], v[116:131]
    ds_read_b64_tr_b16 v[40:41], v162 offset:40960
    ds_read_b64_tr_b16 v[42:43], v163 offset:40960
    v_mfma_f32_32x32x16_bf16 v[132:147], v[52:55], v[20:23], v[132:147]
    s_waitcnt lgkmcnt(8)
    v_mfma_f32_32x32x16_bf16 v[68:83], v[56:59], v[24:27], v[68:83]
    ds_read_b128 v[16:19], v150 offset:32768
    ds_read_b128 v[20:23], v150 offset:36864
    v_mfma_f32_32x32x16_bf16 v[84:99], v[60:63], v[24:27], v[84:99]
    ds_read_b64_tr_b16 v[44:45], v152 offset:50176
    ds_read_b64_tr_b16 v[46:47], v153 offset:51328
    v_mfma_f32_32x32x16_bf16 v[100:115], v[56:59], v[28:31], v[100:115]
    ds_read_b64_tr_b16 v[48:49], v154 offset:50176
    ds_read_b64_tr_b16 v[50:51], v155 offset:51328
    v_mfma_f32_32x32x16_bf16 v[116:131], v[60:63], v[28:31], v[116:131]
    ds_read_b64_tr_b16 v[52:53], v164 offset:40960
    ds_read_b64_tr_b16 v[54:55], v165 offset:40960
    v_mfma_f32_32x32x16_bf16 v[132:147], v[64:67], v[28:31], v[132:147]
    s_waitcnt lgkmcnt(8)
    v_mfma_f32_32x32x16_bf16 v[68:83], v[32:35], v[8:11], v[68:83]
    ds_read_b128 v[24:27], v151 offset:32768
    ds_read_b128 v[28:31], v151 offset:36864
    v_mfma_f32_32x32x16_bf16 v[84:99], v[36:39], v[8:11], v[84:99]
    ds_read_b64_tr_b16 v[56:57], v152 offset:54784
    ds_read_b64_tr_b16 v[58:59], v153 offset:55936
    v_mfma_f32_32x32x16_bf16 v[100:115], v[32:35], v[12:15], v[100:115]
    ds_read_b64_tr_b16 v[60:61], v154 offset:54784
    ds_read_b64_tr_b16 v[62:63], v155 offset:55936
    v_mfma_f32_32x32x16_bf16 v[116:131], v[36:39], v[12:15], v[116:131]
    ds_read_b64_tr_b16 v[64:65], v166 offset:40960
    ds_read_b64_tr_b16 v[66:67], v167 offset:40960
    v_mfma_f32_32x32x16_bf16 v[132:147], v[40:43], v[12:15], v[132:147]
    s_waitcnt lgkmcnt(0)
    s_barrier
    v_mfma_f32_32x32x16_bf16 v[68:83], v[44:47], v[16:19], v[68:83]
    ds_read_b128 v[8:11], v148 offset:49152
    ds_read_b128 v[12:15], v148 offset:53248
    v_mfma_f32_32x32x16_bf16 v[84:99], v[48:51], v[16:19], v[84:99]
    ds_read_b64_tr_b16 v[32:33], v156 offset:0
    ds_read_b64_tr_b16 v[34:35], v157 offset:1152
    v_mfma_f32_32x32x16_bf16 v[100:115], v[44:47], v[20:23], v[100:115]
    ds_read_b64_tr_b16 v[36:37], v158 offset:0
    ds_read_b64_tr_b16 v[38:39], v159 offset:1152
    v_mfma_f32_32x32x16_bf16 v[116:131], v[48:51], v[20:23], v[116:131]
    ds_read_b64_tr_b16 v[40:41], v168 offset:0
    ds_read_b64_tr_b16 v[42:43], v169 offset:0
    v_mfma_f32_32x32x16_bf16 v[132:147], v[52:55], v[20:23], v[132:147]
    v_mfma_f32_32x32x16_bf16 v[68:83], v[56:59], v[24:27], v[68:83]
    ds_read_b128 v[16:19], v149 offset:49152
    ds_read_b128 v[20:23], v149 offset:53248
    v_mfma_f32_32x32x16_bf16 v[84:99], v[60:63], v[24:27], v[84:99]
    ds_read_b64_tr_b16 v[44:45], v156 offset:4608
    ds_read_b64_tr_b16 v[46:47], v157 offset:5760
    v_mfma_f32_32x32x16_bf16 v[100:115], v[56:59], v[28:31], v[100:115]
    ds_read_b64_tr_b16 v[48:49], v158 offset:4608
    ds_read_b64_tr_b16 v[50:51], v159 offset:5760
    v_mfma_f32_32x32x16_bf16 v[116:131], v[60:63], v[28:31], v[116:131]
    ds_read_b64_tr_b16 v[52:53], v170 offset:0
    ds_read_b64_tr_b16 v[54:55], v171 offset:0
    v_mfma_f32_32x32x16_bf16 v[132:147], v[64:67], v[28:31], v[132:147]
    s_waitcnt lgkmcnt(8)
    v_mfma_f32_32x32x16_bf16 v[68:83], v[32:35], v[8:11], v[68:83]
    ds_read_b128 v[24:27], v150 offset:49152
    ds_read_b128 v[28:31], v150 offset:53248
    v_mfma_f32_32x32x16_bf16 v[84:99], v[36:39], v[8:11], v[84:99]
    ds_read_b64_tr_b16 v[56:57], v156 offset:9216
    ds_read_b64_tr_b16 v[58:59], v157 offset:10368
    v_mfma_f32_32x32x16_bf16 v[100:115], v[32:35], v[12:15], v[100:115]
    ds_read_b64_tr_b16 v[60:61], v158 offset:9216
    ds_read_b64_tr_b16 v[62:63], v159 offset:10368
    v_mfma_f32_32x32x16_bf16 v[116:131], v[36:39], v[12:15], v[116:131]
    ds_read_b64_tr_b16 v[64:65], v172 offset:0
    ds_read_b64_tr_b16 v[66:67], v173 offset:0
    v_mfma_f32_32x32x16_bf16 v[132:147], v[40:43], v[12:15], v[132:147]
    s_waitcnt lgkmcnt(8)
    v_mfma_f32_32x32x16_bf16 v[68:83], v[44:47], v[16:19], v[68:83]
    ds_read_b128 v[8:11], v151 offset:49152
    ds_read_b128 v[12:15], v151 offset:53248
    v_mfma_f32_32x32x16_bf16 v[84:99], v[48:51], v[16:19], v[84:99]
    ds_read_b64_tr_b16 v[32:33], v156 offset:13824
    ds_read_b64_tr_b16 v[34:35], v157 offset:14976
    v_mfma_f32_32x32x16_bf16 v[100:115], v[44:47], v[20:23], v[100:115]
    ds_read_b64_tr_b16 v[36:37], v158 offset:13824
    ds_read_b64_tr_b16 v[38:39], v159 offset:14976
    v_mfma_f32_32x32x16_bf16 v[116:131], v[48:51], v[20:23], v[116:131]
    ds_read_b64_tr_b16 v[40:41], v174 offset:0
    ds_read_b64_tr_b16 v[42:43], v175 offset:0
    v_mfma_f32_32x32x16_bf16 v[132:147], v[52:55], v[20:23], v[132:147]
    s_waitcnt lgkmcnt(0)
    s_barrier
    v_mfma_f32_32x32x16_bf16 v[68:83], v[56:59], v[24:27], v[68:83]
    ds_read_b128 v[16:19], v148 offset:0
    ds_read_b128 v[20:23], v148 offset:4096
    v_mfma_f32_32x32x16_bf16 v[84:99], v[60:63], v[24:27], v[84:99]
    ds_read_b64_tr_b16 v[44:45], v152 offset:0
    ds_read_b64_tr_b16 v[46:47], v153 offset:1152
    v_mfma_f32_32x32x16_bf16 v[100:115], v[56:59], v[28:31], v[100:115]
    ds_read_b64_tr_b16 v[48:49], v154 offset:0
    ds_read_b64_tr_b16 v[50:51], v155 offset:1152
    v_mfma_f32_32x32x16_bf16 v[116:131], v[60:63], v[28:31], v[116:131]
    ds_read_b64_tr_b16 v[52:53], v160 offset:0
    ds_read_b64_tr_b16 v[54:55], v161 offset:0
    v_mfma_f32_32x32x16_bf16 v[132:147], v[64:67], v[28:31], v[132:147]
    v_mfma_f32_32x32x16_bf16 v[68:83], v[32:35], v[8:11], v[68:83]
    ds_read_b128 v[24:27], v149 offset:0
    ds_read_b128 v[28:31], v149 offset:4096
    v_mfma_f32_32x32x16_bf16 v[84:99], v[36:39], v[8:11], v[84:99]
    ds_read_b64_tr_b16 v[56:57], v152 offset:4608
    ds_read_b64_tr_b16 v[58:59], v153 offset:5760
    v_mfma_f32_32x32x16_bf16 v[100:115], v[32:35], v[12:15], v[100:115]
    ds_read_b64_tr_b16 v[60:61], v154 offset:4608
    ds_read_b64_tr_b16 v[62:63], v155 offset:5760
    v_mfma_f32_32x32x16_bf16 v[116:131], v[36:39], v[12:15], v[116:131]
    ds_read_b64_tr_b16 v[64:65], v162 offset:0
    ds_read_b64_tr_b16 v[66:67], v163 offset:0
    v_mfma_f32_32x32x16_bf16 v[132:147], v[40:43], v[12:15], v[132:147]
    s_waitcnt lgkmcnt(8)
    v_mfma_f32_32x32x16_bf16 v[68:83], v[44:47], v[16:19], v[68:83]
    ds_read_b128 v[8:11], v150 offset:0
    ds_read_b128 v[12:15], v150 offset:4096
    v_mfma_f32_32x32x16_bf16 v[84:99], v[48:51], v[16:19], v[84:99]
    ds_read_b64_tr_b16 v[32:33], v152 offset:9216
    ds_read_b64_tr_b16 v[34:35], v153 offset:10368
    v_mfma_f32_32x32x16_bf16 v[100:115], v[44:47], v[20:23], v[100:115]
    ds_read_b64_tr_b16 v[36:37], v154 offset:9216
    ds_read_b64_tr_b16 v[38:39], v155 offset:10368
    v_mfma_f32_32x32x16_bf16 v[116:131], v[48:51], v[20:23], v[116:131]
    ds_read_b64_tr_b16 v[40:41], v164 offset:0
    ds_read_b64_tr_b16 v[42:43], v165 offset:0
    v_mfma_f32_32x32x16_bf16 v[132:147], v[52:55], v[20:23], v[132:147]
    s_waitcnt lgkmcnt(8)
    v_mfma_f32_32x32x16_bf16 v[68:83], v[56:59], v[24:27], v[68:83]
    ds_read_b128 v[16:19], v151 offset:0
    ds_read_b128 v[20:23], v151 offset:4096
    v_mfma_f32_32x32x16_bf16 v[84:99], v[60:63], v[24:27], v[84:99]
    ds_read_b64_tr_b16 v[44:45], v152 offset:13824
    ds_read_b64_tr_b16 v[46:47], v153 offset:14976
    v_mfma_f32_32x32x16_bf16 v[100:115], v[56:59], v[28:31], v[100:115]
    ds_read_b64_tr_b16 v[48:49], v154 offset:13824
    ds_read_b64_tr_b16 v[50:51], v155 offset:14976
    v_mfma_f32_32x32x16_bf16 v[116:131], v[60:63], v[28:31], v[116:131]
    ds_read_b64_tr_b16 v[52:53], v166 offset:0
    ds_read_b64_tr_b16 v[54:55], v167 offset:0
    v_mfma_f32_32x32x16_bf16 v[132:147], v[64:67], v[28:31], v[132:147]
    s_waitcnt lgkmcnt(0)
    s_barrier
    v_mfma_f32_32x32x16_bf16 v[68:83], v[32:35], v[8:11], v[68:83]
    ds_read_b128 v[24:27], v148 offset:16384
    ds_read_b128 v[28:31], v148 offset:20480
    v_mfma_f32_32x32x16_bf16 v[84:99], v[36:39], v[8:11], v[84:99]
    ds_read_b64_tr_b16 v[56:57], v152 offset:20480
    ds_read_b64_tr_b16 v[58:59], v153 offset:21632
    v_mfma_f32_32x32x16_bf16 v[100:115], v[32:35], v[12:15], v[100:115]
    ds_read_b64_tr_b16 v[60:61], v154 offset:20480
    ds_read_b64_tr_b16 v[62:63], v155 offset:21632
    v_mfma_f32_32x32x16_bf16 v[116:131], v[36:39], v[12:15], v[116:131]
    ds_read_b64_tr_b16 v[64:65], v160 offset:20480
    ds_read_b64_tr_b16 v[66:67], v161 offset:20480
    v_mfma_f32_32x32x16_bf16 v[132:147], v[40:43], v[12:15], v[132:147]
    v_mfma_f32_32x32x16_bf16 v[68:83], v[44:47], v[16:19], v[68:83]
    ds_read_b128 v[8:11], v149 offset:16384
    ds_read_b128 v[12:15], v149 offset:20480
    v_mfma_f32_32x32x16_bf16 v[84:99], v[48:51], v[16:19], v[84:99]
    ds_read_b64_tr_b16 v[32:33], v152 offset:25088
    ds_read_b64_tr_b16 v[34:35], v153 offset:26240
    v_mfma_f32_32x32x16_bf16 v[100:115], v[44:47], v[20:23], v[100:115]
    ds_read_b64_tr_b16 v[36:37], v154 offset:25088
    ds_read_b64_tr_b16 v[38:39], v155 offset:26240
    v_mfma_f32_32x32x16_bf16 v[116:131], v[48:51], v[20:23], v[116:131]
    ds_read_b64_tr_b16 v[40:41], v162 offset:20480
    ds_read_b64_tr_b16 v[42:43], v163 offset:20480
    v_mfma_f32_32x32x16_bf16 v[132:147], v[52:55], v[20:23], v[132:147]
    s_waitcnt lgkmcnt(8)
    v_mfma_f32_32x32x16_bf16 v[68:83], v[56:59], v[24:27], v[68:83]
    ds_read_b128 v[16:19], v150 offset:16384
    ds_read_b128 v[20:23], v150 offset:20480
    v_mfma_f32_32x32x16_bf16 v[84:99], v[60:63], v[24:27], v[84:99]
    ds_read_b64_tr_b16 v[44:45], v152 offset:29696
    ds_read_b64_tr_b16 v[46:47], v153 offset:30848
    v_mfma_f32_32x32x16_bf16 v[100:115], v[56:59], v[28:31], v[100:115]
    ds_read_b64_tr_b16 v[48:49], v154 offset:29696
    ds_read_b64_tr_b16 v[50:51], v155 offset:30848
    v_mfma_f32_32x32x16_bf16 v[116:131], v[60:63], v[28:31], v[116:131]
    ds_read_b64_tr_b16 v[52:53], v164 offset:20480
    ds_read_b64_tr_b16 v[54:55], v165 offset:20480
    v_mfma_f32_32x32x16_bf16 v[132:147], v[64:67], v[28:31], v[132:147]
    s_waitcnt lgkmcnt(8)
    v_mfma_f32_32x32x16_bf16 v[68:83], v[32:35], v[8:11], v[68:83]
    ds_read_b128 v[24:27], v151 offset:16384
    ds_read_b128 v[28:31], v151 offset:20480
    v_mfma_f32_32x32x16_bf16 v[84:99], v[36:39], v[8:11], v[84:99]
    ds_read_b64_tr_b16 v[56:57], v152 offset:34304
    ds_read_b64_tr_b16 v[58:59], v153 offset:35456
    v_mfma_f32_32x32x16_bf16 v[100:115], v[32:35], v[12:15], v[100:115]
    ds_read_b64_tr_b16 v[60:61], v154 offset:34304
    ds_read_b64_tr_b16 v[62:63], v155 offset:35456
    v_mfma_f32_32x32x16_bf16 v[116:131], v[36:39], v[12:15], v[116:131]
    ds_read_b64_tr_b16 v[64:65], v166 offset:20480
    ds_read_b64_tr_b16 v[66:67], v167 offset:20480
    v_mfma_f32_32x32x16_bf16 v[132:147], v[40:43], v[12:15], v[132:147]
    s_waitcnt lgkmcnt(0)
    s_barrier
    v_mfma_f32_32x32x16_bf16 v[68:83], v[44:47], v[16:19], v[68:83]
    ds_read_b128 v[8:11], v148 offset:32768
    ds_read_b128 v[12:15], v148 offset:36864
    v_mfma_f32_32x32x16_bf16 v[84:99], v[48:51], v[16:19], v[84:99]
    ds_read_b64_tr_b16 v[32:33], v152 offset:40960
    ds_read_b64_tr_b16 v[34:35], v153 offset:42112
    v_mfma_f32_32x32x16_bf16 v[100:115], v[44:47], v[20:23], v[100:115]
    ds_read_b64_tr_b16 v[36:37], v154 offset:40960
    ds_read_b64_tr_b16 v[38:39], v155 offset:42112
    v_mfma_f32_32x32x16_bf16 v[116:131], v[48:51], v[20:23], v[116:131]
    ds_read_b64_tr_b16 v[40:41], v160 offset:40960
    ds_read_b64_tr_b16 v[42:43], v161 offset:40960
    v_mfma_f32_32x32x16_bf16 v[132:147], v[52:55], v[20:23], v[132:147]
    v_mfma_f32_32x32x16_bf16 v[68:83], v[56:59], v[24:27], v[68:83]
    ds_read_b128 v[16:19], v149 offset:32768
    ds_read_b128 v[20:23], v149 offset:36864
    v_mfma_f32_32x32x16_bf16 v[84:99], v[60:63], v[24:27], v[84:99]
    ds_read_b64_tr_b16 v[44:45], v152 offset:45568
    ds_read_b64_tr_b16 v[46:47], v153 offset:46720
    v_mfma_f32_32x32x16_bf16 v[100:115], v[56:59], v[28:31], v[100:115]
    ds_read_b64_tr_b16 v[48:49], v154 offset:45568
    ds_read_b64_tr_b16 v[50:51], v155 offset:46720
    v_mfma_f32_32x32x16_bf16 v[116:131], v[60:63], v[28:31], v[116:131]
    ds_read_b64_tr_b16 v[52:53], v162 offset:40960
    ds_read_b64_tr_b16 v[54:55], v163 offset:40960
    v_mfma_f32_32x32x16_bf16 v[132:147], v[64:67], v[28:31], v[132:147]
    s_waitcnt lgkmcnt(8)
    buffer_load_dword v194, v195, s[28:31], 0 offen sc1
    v_mfma_f32_32x32x16_bf16 v[68:83], v[32:35], v[8:11], v[68:83]
    ds_read_b128 v[24:27], v150 offset:32768
    ds_read_b128 v[28:31], v150 offset:36864
    v_mfma_f32_32x32x16_bf16 v[84:99], v[36:39], v[8:11], v[84:99]
    ds_read_b64_tr_b16 v[56:57], v152 offset:50176
    ds_read_b64_tr_b16 v[58:59], v153 offset:51328
    v_mfma_f32_32x32x16_bf16 v[100:115], v[32:35], v[12:15], v[100:115]
    ds_read_b64_tr_b16 v[60:61], v154 offset:50176
    ds_read_b64_tr_b16 v[62:63], v155 offset:51328
    v_mfma_f32_32x32x16_bf16 v[116:131], v[36:39], v[12:15], v[116:131]
    ds_read_b64_tr_b16 v[64:65], v164 offset:40960
    ds_read_b64_tr_b16 v[66:67], v165 offset:40960
    v_mfma_f32_32x32x16_bf16 v[132:147], v[40:43], v[12:15], v[132:147]
    s_waitcnt lgkmcnt(8)
    v_mfma_f32_32x32x16_bf16 v[68:83], v[44:47], v[16:19], v[68:83]
    ds_read_b128 v[8:11], v151 offset:32768
    ds_read_b128 v[12:15], v151 offset:36864
    v_mfma_f32_32x32x16_bf16 v[84:99], v[48:51], v[16:19], v[84:99]
    ds_read_b64_tr_b16 v[32:33], v152 offset:54784
    ds_read_b64_tr_b16 v[34:35], v153 offset:55936
    v_mfma_f32_32x32x16_bf16 v[100:115], v[44:47], v[20:23], v[100:115]
    ds_read_b64_tr_b16 v[36:37], v154 offset:54784
    ds_read_b64_tr_b16 v[38:39], v155 offset:55936
    v_mfma_f32_32x32x16_bf16 v[116:131], v[48:51], v[20:23], v[116:131]
    ds_read_b64_tr_b16 v[40:41], v166 offset:40960
    ds_read_b64_tr_b16 v[42:43], v167 offset:40960
    v_mfma_f32_32x32x16_bf16 v[132:147], v[52:55], v[20:23], v[132:147]
    s_waitcnt lgkmcnt(0)
    s_barrier
    v_mfma_f32_32x32x16_bf16 v[68:83], v[56:59], v[24:27], v[68:83]
    ds_read_b128 v[16:19], v148 offset:49152
    ds_read_b128 v[20:23], v148 offset:53248
    v_mfma_f32_32x32x16_bf16 v[84:99], v[60:63], v[24:27], v[84:99]
    ds_read_b64_tr_b16 v[44:45], v156 offset:0
    ds_read_b64_tr_b16 v[46:47], v157 offset:1152
    v_mfma_f32_32x32x16_bf16 v[100:115], v[56:59], v[28:31], v[100:115]
    ds_read_b64_tr_b16 v[48:49], v158 offset:0
    ds_read_b64_tr_b16 v[50:51], v159 offset:1152
    v_mfma_f32_32x32x16_bf16 v[116:131], v[60:63], v[28:31], v[116:131]
    ds_read_b64_tr_b16 v[52:53], v168 offset:0
    ds_read_b64_tr_b16 v[54:55], v169 offset:0
    v_mfma_f32_32x32x16_bf16 v[132:147], v[64:67], v[28:31], v[132:147]
    v_mfma_f32_32x32x16_bf16 v[68:83], v[32:35], v[8:11], v[68:83]
    ds_read_b128 v[24:27], v149 offset:49152
    ds_read_b128 v[28:31], v149 offset:53248
    v_mfma_f32_32x32x16_bf16 v[84:99], v[36:39], v[8:11], v[84:99]
    ds_read_b64_tr_b16 v[56:57], v156 offset:4608
    ds_read_b64_tr_b16 v[58:59], v157 offset:5760
    v_mfma_f32_32x32x16_bf16 v[100:115], v[32:35], v[12:15], v[100:115]
    ds_read_b64_tr_b16 v[60:61], v158 offset:4608
    ds_read_b64_tr_b16 v[62:63], v159 offset:5760
    v_mfma_f32_32x32x16_bf16 v[116:131], v[36:39], v[12:15], v[116:131]
    ds_read_b64_tr_b16 v[64:65], v170 offset:0
    ds_read_b64_tr_b16 v[66:67], v171 offset:0
    v_mfma_f32_32x32x16_bf16 v[132:147], v[40:43], v[12:15], v[132:147]
    s_waitcnt lgkmcnt(8)
    v_mfma_f32_32x32x16_bf16 v[68:83], v[44:47], v[16:19], v[68:83]
    ds_read_b128 v[8:11], v150 offset:49152
    ds_read_b128 v[12:15], v150 offset:53248
    v_mfma_f32_32x32x16_bf16 v[84:99], v[48:51], v[16:19], v[84:99]
    ds_read_b64_tr_b16 v[32:33], v156 offset:9216
    ds_read_b64_tr_b16 v[34:35], v157 offset:10368
    v_mfma_f32_32x32x16_bf16 v[100:115], v[44:47], v[20:23], v[100:115]
    ds_read_b64_tr_b16 v[36:37], v158 offset:9216
    ds_read_b64_tr_b16 v[38:39], v159 offset:10368
    v_mfma_f32_32x32x16_bf16 v[116:131], v[48:51], v[20:23], v[116:131]
    ds_read_b64_tr_b16 v[40:41], v172 offset:0
    ds_read_b64_tr_b16 v[42:43], v173 offset:0
    v_mfma_f32_32x32x16_bf16 v[132:147], v[52:55], v[20:23], v[132:147]
    s_waitcnt lgkmcnt(8)
    v_mfma_f32_32x32x16_bf16 v[68:83], v[56:59], v[24:27], v[68:83]
    ds_read_b128 v[16:19], v151 offset:49152
    ds_read_b128 v[20:23], v151 offset:53248
    v_mfma_f32_32x32x16_bf16 v[84:99], v[60:63], v[24:27], v[84:99]
    ds_read_b64_tr_b16 v[44:45], v156 offset:13824
    ds_read_b64_tr_b16 v[46:47], v157 offset:14976
    v_mfma_f32_32x32x16_bf16 v[100:115], v[56:59], v[28:31], v[100:115]
    ds_read_b64_tr_b16 v[48:49], v158 offset:13824
    ds_read_b64_tr_b16 v[50:51], v159 offset:14976
    v_mfma_f32_32x32x16_bf16 v[116:131], v[60:63], v[28:31], v[116:131]
    ds_read_b64_tr_b16 v[52:53], v174 offset:0
    ds_read_b64_tr_b16 v[54:55], v175 offset:0
    v_mfma_f32_32x32x16_bf16 v[132:147], v[64:67], v[28:31], v[132:147]
    s_waitcnt lgkmcnt(0)
    s_barrier
    v_mfma_f32_32x32x16_bf16 v[68:83], v[32:35], v[8:11], v[68:83]
    ds_read_b128 v[24:27], v148 offset:0
    ds_read_b128 v[28:31], v148 offset:4096
    v_mfma_f32_32x32x16_bf16 v[84:99], v[36:39], v[8:11], v[84:99]
    ds_read_b64_tr_b16 v[56:57], v152 offset:0
    ds_read_b64_tr_b16 v[58:59], v153 offset:1152
    v_mfma_f32_32x32x16_bf16 v[100:115], v[32:35], v[12:15], v[100:115]
    ds_read_b64_tr_b16 v[60:61], v154 offset:0
    ds_read_b64_tr_b16 v[62:63], v155 offset:1152
    v_mfma_f32_32x32x16_bf16 v[116:131], v[36:39], v[12:15], v[116:131]
    ds_read_b64_tr_b16 v[64:65], v160 offset:0
    ds_read_b64_tr_b16 v[66:67], v161 offset:0
    v_mfma_f32_32x32x16_bf16 v[132:147], v[40:43], v[12:15], v[132:147]
    v_mfma_f32_32x32x16_bf16 v[68:83], v[44:47], v[16:19], v[68:83]
    ds_read_b128 v[8:11], v149 offset:0
    ds_read_b128 v[12:15], v149 offset:4096
    v_mfma_f32_32x32x16_bf16 v[84:99], v[48:51], v[16:19], v[84:99]
    ds_read_b64_tr_b16 v[32:33], v152 offset:4608
    ds_read_b64_tr_b16 v[34:35], v153 offset:5760
    v_mfma_f32_32x32x16_bf16 v[100:115], v[44:47], v[20:23], v[100:115]
    ds_read_b64_tr_b16 v[36:37], v154 offset:4608
    ds_read_b64_tr_b16 v[38:39], v155 offset:5760
    v_mfma_f32_32x32x16_bf16 v[116:131], v[48:51], v[20:23], v[116:131]
    ds_read_b64_tr_b16 v[40:41], v162 offset:0
    ds_read_b64_tr_b16 v[42:43], v163 offset:0
    v_mfma_f32_32x32x16_bf16 v[132:147], v[52:55], v[20:23], v[132:147]
    s_waitcnt lgkmcnt(8)
    v_mfma_f32_32x32x16_bf16 v[68:83], v[56:59], v[24:27], v[68:83]
    ds_read_b128 v[16:19], v150 offset:0
    ds_read_b128 v[20:23], v150 offset:4096
    v_mfma_f32_32x32x16_bf16 v[84:99], v[60:63], v[24:27], v[84:99]
    ds_read_b64_tr_b16 v[44:45], v152 offset:9216
    ds_read_b64_tr_b16 v[46:47], v153 offset:10368
    v_mfma_f32_32x32x16_bf16 v[100:115], v[56:59], v[28:31], v[100:115]
    ds_read_b64_tr_b16 v[48:49], v154 offset:9216
    ds_read_b64_tr_b16 v[50:51], v155 offset:10368
    v_mfma_f32_32x32x16_bf16 v[116:131], v[60:63], v[28:31], v[116:131]
    ds_read_b64_tr_b16 v[52:53], v164 offset:0
    ds_read_b64_tr_b16 v[54:55], v165 offset:0
    v_mfma_f32_32x32x16_bf16 v[132:147], v[64:67], v[28:31], v[132:147]
    s_waitcnt lgkmcnt(8)
    v_mfma_f32_32x32x16_bf16 v[68:83], v[32:35], v[8:11], v[68:83]
    ds_read_b128 v[24:27], v151 offset:0
    ds_read_b128 v[28:31], v151 offset:4096
    v_mfma_f32_32x32x16_bf16 v[84:99], v[36:39], v[8:11], v[84:99]
    ds_read_b64_tr_b16 v[56:57], v152 offset:13824
    ds_read_b64_tr_b16 v[58:59], v153 offset:14976
    v_mfma_f32_32x32x16_bf16 v[100:115], v[32:35], v[12:15], v[100:115]
    ds_read_b64_tr_b16 v[60:61], v154 offset:13824
    ds_read_b64_tr_b16 v[62:63], v155 offset:14976
    v_mfma_f32_32x32x16_bf16 v[116:131], v[36:39], v[12:15], v[116:131]
    ds_read_b64_tr_b16 v[64:65], v166 offset:0
    ds_read_b64_tr_b16 v[66:67], v167 offset:0
    v_mfma_f32_32x32x16_bf16 v[132:147], v[40:43], v[12:15], v[132:147]
    s_waitcnt lgkmcnt(0)
    s_barrier
    v_mfma_f32_32x32x16_bf16 v[68:83], v[44:47], v[16:19], v[68:83]
    v_mfma_f32_32x32x16_bf16 v[84:99], v[48:51], v[16:19], v[84:99]
    v_mfma_f32_32x32x16_bf16 v[100:115], v[44:47], v[20:23], v[100:115]
    v_mfma_f32_32x32x16_bf16 v[116:131], v[48:51], v[20:23], v[116:131]
    v_mfma_f32_32x32x16_bf16 v[132:147], v[52:55], v[20:23], v[132:147]
    v_mfma_f32_32x32x16_bf16 v[68:83], v[56:59], v[24:27], v[68:83]
    v_mfma_f32_32x32x16_bf16 v[84:99], v[60:63], v[24:27], v[84:99]
    v_mfma_f32_32x32x16_bf16 v[100:115], v[56:59], v[28:31], v[100:115]
    v_mfma_f32_32x32x16_bf16 v[116:131], v[60:63], v[28:31], v[116:131]
    v_mfma_f32_32x32x16_bf16 v[132:147], v[64:67], v[28:31], v[132:147]
proj_a_qepi:
    s_nop 7
    s_nop 7
    s_waitcnt vmcnt(0)
    v_readfirstlane_b32 s99, v194
    s_nop 3
    s_cmp_ge_u32 s99, 4
    s_cbranch_scc1 proj_vm1
    s_load_dwordx2 s[42:43], s[0:1], 80
    s_waitcnt lgkmcnt(0)
    s_mov_b32 s28, s42
    s_and_b32 s29, s43, 0xffff
    s_mov_b32 s30, 256
    s_mov_b32 s31, 0x20000
    v_mov_b32 v191, 0
    s_mov_b32 s98, 0
proj_mk2:
    buffer_load_dword v190, v191, s[28:31], 0 offen sc1
    s_waitcnt vmcnt(0)
    v_readfirstlane_b32 s99, v190
    s_nop 3
    s_cmp_ge_u32 s99, 4
    s_cbranch_scc1 proj_mk2_ok
    s_add_u32 s98, s98, 1
    s_cmp_lt_u32 s98, 0x40000
    s_cbranch_scc0 proj_mk2_ok
    s_sleep 2
    s_branch proj_mk2
proj_mk2_ok:
proj_vm1:
    s_and_b32 s42, s14, 1
    s_lshl_b32 s43, s42, 1
    s_add_u32 s45, s43, s47
    s_lshl_b32 s46, s12, 2
    s_add_u32 s46, s46, s45
    s_cmp_ge_u32 s13, 4
    s_cbranch_scc0 proj_nophi
    v_mov_b32 v186, 1069066811
    v_mov_b32 v187, 1069066811
    v_mov_b32 v188, 897988541
    v_mov_b32 v189, 897988541
    v_pk_mul_f32 v[16:17], v[68:69], v[186:187]
    v_pk_mul_f32 v[18:19], v[70:71], v[186:187]
    v_pk_mul_f32 v[20:21], v[72:73], v[186:187]
    v_pk_mul_f32 v[22:23], v[74:75], v[186:187]
    v_pk_mul_f32 v[24:25], v[76:77], v[186:187]
    v_pk_mul_f32 v[26:27], v[78:79], v[186:187]
    v_pk_mul_f32 v[28:29], v[80:81], v[186:187]
    v_pk_mul_f32 v[30:31], v[82:83], v[186:187]
    v_exp_f32 v16, v16 clamp
    v_exp_f32 v17, v17 clamp
    v_exp_f32 v18, v18 clamp
    v_exp_f32 v19, v19 clamp
    v_exp_f32 v20, v20 clamp
    v_exp_f32 v21, v21 clamp
    v_exp_f32 v22, v22 clamp
    v_exp_f32 v23, v23 clamp
    v_exp_f32 v24, v24 clamp
    v_exp_f32 v25, v25 clamp
    v_exp_f32 v26, v26 clamp
    v_exp_f32 v27, v27 clamp
    v_exp_f32 v28, v28 clamp
    v_exp_f32 v29, v29 clamp
    v_exp_f32 v30, v30 clamp
    v_exp_f32 v31, v31 clamp
    v_max_f32 v68, 0, v68
    v_max_f32 v69, 0, v69
    v_max_f32 v70, 0, v70
    v_max_f32 v71, 0, v71
    v_max_f32 v72, 0, v72
    v_max_f32 v73, 0, v73
    v_max_f32 v74, 0, v74
    v_max_f32 v75, 0, v75
    v_max_f32 v76, 0, v76
    v_max_f32 v77, 0, v77
    v_max_f32 v78, 0, v78
    v_max_f32 v79, 0, v79
    v_max_f32 v80, 0, v80
    v_max_f32 v81, 0, v81
    v_max_f32 v82, 0, v82
    v_max_f32 v83, 0, v83
    v_pk_add_f32 v[16:17], v[16:17], v[188:189]
    v_pk_add_f32 v[18:19], v[18:19], v[188:189]
    v_pk_add_f32 v[20:21], v[20:21], v[188:189]
    v_pk_add_f32 v[22:23], v[22:23], v[188:189]
    v_pk_add_f32 v[24:25], v[24:25], v[188:189]
    v_pk_add_f32 v[26:27], v[26:27], v[188:189]
    v_pk_add_f32 v[28:29], v[28:29], v[188:189]
    v_pk_add_f32 v[30:31], v[30:31], v[188:189]
    v_pk_add_f32 v[68:69], v[68:69], v[16:17]
    v_pk_add_f32 v[70:71], v[70:71], v[18:19]
    v_pk_add_f32 v[72:73], v[72:73], v[20:21]
    v_pk_add_f32 v[74:75], v[74:75], v[22:23]
    v_pk_add_f32 v[76:77], v[76:77], v[24:25]
    v_pk_add_f32 v[78:79], v[78:79], v[26:27]
    v_pk_add_f32 v[80:81], v[80:81], v[28:29]
    v_pk_add_f32 v[82:83], v[82:83], v[30:31]
    v_mov_b32 v186, 1069066811
    v_mov_b32 v187, 1069066811
    v_mov_b32 v188, 897988541
    v_mov_b32 v189, 897988541
    v_pk_mul_f32 v[16:17], v[84:85], v[186:187]
    v_pk_mul_f32 v[18:19], v[86:87], v[186:187]
    v_pk_mul_f32 v[20:21], v[88:89], v[186:187]
    v_pk_mul_f32 v[22:23], v[90:91], v[186:187]
    v_pk_mul_f32 v[24:25], v[92:93], v[186:187]
    v_pk_mul_f32 v[26:27], v[94:95], v[186:187]
    v_pk_mul_f32 v[28:29], v[96:97], v[186:187]
    v_pk_mul_f32 v[30:31], v[98:99], v[186:187]
    v_exp_f32 v16, v16 clamp
    v_exp_f32 v17, v17 clamp
    v_exp_f32 v18, v18 clamp
    v_exp_f32 v19, v19 clamp
    v_exp_f32 v20, v20 clamp
    v_exp_f32 v21, v21 clamp
    v_exp_f32 v22, v22 clamp
    v_exp_f32 v23, v23 clamp
    v_exp_f32 v24, v24 clamp
    v_exp_f32 v25, v25 clamp
    v_exp_f32 v26, v26 clamp
    v_exp_f32 v27, v27 clamp
    v_exp_f32 v28, v28 clamp
    v_exp_f32 v29, v29 clamp
    v_exp_f32 v30, v30 clamp
    v_exp_f32 v31, v31 clamp
    v_max_f32 v84, 0, v84
    v_max_f32 v85, 0, v85
    v_max_f32 v86, 0, v86
    v_max_f32 v87, 0, v87
    v_max_f32 v88, 0, v88
    v_max_f32 v89, 0, v89
    v_max_f32 v90, 0, v90
    v_max_f32 v91, 0, v91
    v_max_f32 v92, 0, v92
    v_max_f32 v93, 0, v93
    v_max_f32 v94, 0, v94
    v_max_f32 v95, 0, v95
    v_max_f32 v96, 0, v96
    v_max_f32 v97, 0, v97
    v_max_f32 v98, 0, v98
    v_max_f32 v99, 0, v99
    v_pk_add_f32 v[16:17], v[16:17], v[188:189]
    v_pk_add_f32 v[18:19], v[18:19], v[188:189]
    v_pk_add_f32 v[20:21], v[20:21], v[188:189]
    v_pk_add_f32 v[22:23], v[22:23], v[188:189]
    v_pk_add_f32 v[24:25], v[24:25], v[188:189]
    v_pk_add_f32 v[26:27], v[26:27], v[188:189]
    v_pk_add_f32 v[28:29], v[28:29], v[188:189]
    v_pk_add_f32 v[30:31], v[30:31], v[188:189]
    v_pk_add_f32 v[84:85], v[84:85], v[16:17]
    v_pk_add_f32 v[86:87], v[86:87], v[18:19]
    v_pk_add_f32 v[88:89], v[88:89], v[20:21]
    v_pk_add_f32 v[90:91], v[90:91], v[22:23]
    v_pk_add_f32 v[92:93], v[92:93], v[24:25]
    v_pk_add_f32 v[94:95], v[94:95], v[26:27]
    v_pk_add_f32 v[96:97], v[96:97], v[28:29]
    v_pk_add_f32 v[98:99], v[98:99], v[30:31]
    v_mov_b32 v186, 1069066811
    v_mov_b32 v187, 1069066811
    v_mov_b32 v188, 897988541
    v_mov_b32 v189, 897988541
    v_pk_mul_f32 v[16:17], v[100:101], v[186:187]
    v_pk_mul_f32 v[18:19], v[102:103], v[186:187]
    v_pk_mul_f32 v[20:21], v[104:105], v[186:187]
    v_pk_mul_f32 v[22:23], v[106:107], v[186:187]
    v_pk_mul_f32 v[24:25], v[108:109], v[186:187]
    v_pk_mul_f32 v[26:27], v[110:111], v[186:187]
    v_pk_mul_f32 v[28:29], v[112:113], v[186:187]
    v_pk_mul_f32 v[30:31], v[114:115], v[186:187]
    v_exp_f32 v16, v16 clamp
    v_exp_f32 v17, v17 clamp
    v_exp_f32 v18, v18 clamp
    v_exp_f32 v19, v19 clamp
    v_exp_f32 v20, v20 clamp
    v_exp_f32 v21, v21 clamp
    v_exp_f32 v22, v22 clamp
    v_exp_f32 v23, v23 clamp
    v_exp_f32 v24, v24 clamp
    v_exp_f32 v25, v25 clamp
    v_exp_f32 v26, v26 clamp
    v_exp_f32 v27, v27 clamp
    v_exp_f32 v28, v28 clamp
    v_exp_f32 v29, v29 clamp
    v_exp_f32 v30, v30 clamp
    v_exp_f32 v31, v31 clamp
    v_max_f32 v100, 0, v100
    v_max_f32 v101, 0, v101
    v_max_f32 v102, 0, v102
    v_max_f32 v103, 0, v103
    v_max_f32 v104, 0, v104
    v_max_f32 v105, 0, v105
    v_max_f32 v106, 0, v106
    v_max_f32 v107, 0, v107
    v_max_f32 v108, 0, v108
    v_max_f32 v109, 0, v109
    v_max_f32 v110, 0, v110
    v_max_f32 v111, 0, v111
    v_max_f32 v112, 0, v112
    v_max_f32 v113, 0, v113
    v_max_f32 v114, 0, v114
    v_max_f32 v115, 0, v115
    v_pk_add_f32 v[16:17], v[16:17], v[188:189]
    v_pk_add_f32 v[18:19], v[18:19], v[188:189]
    v_pk_add_f32 v[20:21], v[20:21], v[188:189]
    v_pk_add_f32 v[22:23], v[22:23], v[188:189]
    v_pk_add_f32 v[24:25], v[24:25], v[188:189]
    v_pk_add_f32 v[26:27], v[26:27], v[188:189]
    v_pk_add_f32 v[28:29], v[28:29], v[188:189]
    v_pk_add_f32 v[30:31], v[30:31], v[188:189]
    v_pk_add_f32 v[100:101], v[100:101], v[16:17]
    v_pk_add_f32 v[102:103], v[102:103], v[18:19]
    v_pk_add_f32 v[104:105], v[104:105], v[20:21]
    v_pk_add_f32 v[106:107], v[106:107], v[22:23]
    v_pk_add_f32 v[108:109], v[108:109], v[24:25]
    v_pk_add_f32 v[110:111], v[110:111], v[26:27]
    v_pk_add_f32 v[112:113], v[112:113], v[28:29]
    v_pk_add_f32 v[114:115], v[114:115], v[30:31]
    v_mov_b32 v186, 1069066811
    v_mov_b32 v187, 1069066811
    v_mov_b32 v188, 897988541
    v_mov_b32 v189, 897988541
    v_pk_mul_f32 v[16:17], v[116:117], v[186:187]
    v_pk_mul_f32 v[18:19], v[118:119], v[186:187]
    v_pk_mul_f32 v[20:21], v[120:121], v[186:187]
    v_pk_mul_f32 v[22:23], v[122:123], v[186:187]
    v_pk_mul_f32 v[24:25], v[124:125], v[186:187]
    v_pk_mul_f32 v[26:27], v[126:127], v[186:187]
    v_pk_mul_f32 v[28:29], v[128:129], v[186:187]
    v_pk_mul_f32 v[30:31], v[130:131], v[186:187]
    v_exp_f32 v16, v16 clamp
    v_exp_f32 v17, v17 clamp
    v_exp_f32 v18, v18 clamp
    v_exp_f32 v19, v19 clamp
    v_exp_f32 v20, v20 clamp
    v_exp_f32 v21, v21 clamp
    v_exp_f32 v22, v22 clamp
    v_exp_f32 v23, v23 clamp
    v_exp_f32 v24, v24 clamp
    v_exp_f32 v25, v25 clamp
    v_exp_f32 v26, v26 clamp
    v_exp_f32 v27, v27 clamp
    v_exp_f32 v28, v28 clamp
    v_exp_f32 v29, v29 clamp
    v_exp_f32 v30, v30 clamp
    v_exp_f32 v31, v31 clamp
    v_max_f32 v116, 0, v116
    v_max_f32 v117, 0, v117
    v_max_f32 v118, 0, v118
    v_max_f32 v119, 0, v119
    v_max_f32 v120, 0, v120
    v_max_f32 v121, 0, v121
    v_max_f32 v122, 0, v122
    v_max_f32 v123, 0, v123
    v_max_f32 v124, 0, v124
    v_max_f32 v125, 0, v125
    v_max_f32 v126, 0, v126
    v_max_f32 v127, 0, v127
    v_max_f32 v128, 0, v128
    v_max_f32 v129, 0, v129
    v_max_f32 v130, 0, v130
    v_max_f32 v131, 0, v131
    v_pk_add_f32 v[16:17], v[16:17], v[188:189]
    v_pk_add_f32 v[18:19], v[18:19], v[188:189]
    v_pk_add_f32 v[20:21], v[20:21], v[188:189]
    v_pk_add_f32 v[22:23], v[22:23], v[188:189]
    v_pk_add_f32 v[24:25], v[24:25], v[188:189]
    v_pk_add_f32 v[26:27], v[26:27], v[188:189]
    v_pk_add_f32 v[28:29], v[28:29], v[188:189]
    v_pk_add_f32 v[30:31], v[30:31], v[188:189]
    v_pk_add_f32 v[116:117], v[116:117], v[16:17]
    v_pk_add_f32 v[118:119], v[118:119], v[18:19]
    v_pk_add_f32 v[120:121], v[120:121], v[20:21]
    v_pk_add_f32 v[122:123], v[122:123], v[22:23]
    v_pk_add_f32 v[124:125], v[124:125], v[24:25]
    v_pk_add_f32 v[126:127], v[126:127], v[26:27]
    v_pk_add_f32 v[128:129], v[128:129], v[28:29]
    v_pk_add_f32 v[130:131], v[130:131], v[30:31]
    v_mov_b32 v186, 1069066811
    v_mov_b32 v187, 1069066811
    v_mov_b32 v188, 897988541
    v_mov_b32 v189, 897988541
    v_pk_mul_f32 v[16:17], v[132:133], v[186:187]
    v_pk_mul_f32 v[18:19], v[134:135], v[186:187]
    v_pk_mul_f32 v[20:21], v[136:137], v[186:187]
    v_pk_mul_f32 v[22:23], v[138:139], v[186:187]
    v_exp_f32 v16, v16 clamp
    v_exp_f32 v17, v17 clamp
    v_exp_f32 v18, v18 clamp
    v_exp_f32 v19, v19 clamp
    v_exp_f32 v20, v20 clamp
    v_exp_f32 v21, v21 clamp
    v_exp_f32 v22, v22 clamp
    v_exp_f32 v23, v23 clamp
    v_max_f32 v132, 0, v132
    v_max_f32 v133, 0, v133
    v_max_f32 v134, 0, v134
    v_max_f32 v135, 0, v135
    v_max_f32 v136, 0, v136
    v_max_f32 v137, 0, v137
    v_max_f32 v138, 0, v138
    v_max_f32 v139, 0, v139
    v_pk_add_f32 v[16:17], v[16:17], v[188:189]
    v_pk_add_f32 v[18:19], v[18:19], v[188:189]
    v_pk_add_f32 v[20:21], v[20:21], v[188:189]
    v_pk_add_f32 v[22:23], v[22:23], v[188:189]
    v_pk_add_f32 v[132:133], v[132:133], v[16:17]
    v_pk_add_f32 v[134:135], v[134:135], v[18:19]
    v_pk_add_f32 v[136:137], v[136:137], v[20:21]
    v_pk_add_f32 v[138:139], v[138:139], v[22:23]
proj_nophi:
    s_mul_i32 s42, s42, 20992
    s_lshl_b32 s43, s47, 6
    s_add_u32 s42, s42, s43
    v_mul_u32_u24 v176, 328, v1
    v_lshlrev_b32 v177, 3, v2
    v_add_u32 v176, v176, v177
    v_add_u32 v177, s42, v176
    v_cvt_pk_bf16_f32 v68, v68, v69
    v_cvt_pk_bf16_f32 v69, v70, v71
    ds_write_b64 v177, v[68:69] offset:0
    v_cvt_pk_bf16_f32 v72, v72, v73
    v_cvt_pk_bf16_f32 v73, v74, v75
    ds_write_b64 v177, v[72:73] offset:16
    v_cvt_pk_bf16_f32 v76, v76, v77
    v_cvt_pk_bf16_f32 v77, v78, v79
    ds_write_b64 v177, v[76:77] offset:32
    v_cvt_pk_bf16_f32 v80, v80, v81
    v_cvt_pk_bf16_f32 v81, v82, v83
    ds_write_b64 v177, v[80:81] offset:48
    v_cvt_pk_bf16_f32 v84, v84, v85
    v_cvt_pk_bf16_f32 v85, v86, v87
    ds_write_b64 v177, v[84:85] offset:128
    v_cvt_pk_bf16_f32 v88, v88, v89
    v_cvt_pk_bf16_f32 v89, v90, v91
    ds_write_b64 v177, v[88:89] offset:144
    v_cvt_pk_bf16_f32 v92, v92, v93
    v_cvt_pk_bf16_f32 v93, v94, v95
    ds_write_b64 v177, v[92:93] offset:160
    v_cvt_pk_bf16_f32 v96, v96, v97
    v_cvt_pk_bf16_f32 v97, v98, v99
    ds_write_b64 v177, v[96:97] offset:176
    v_cvt_pk_bf16_f32 v100, v100, v101
    v_cvt_pk_bf16_f32 v101, v102, v103
    ds_write_b64 v177, v[100:101] offset:10496
    v_cvt_pk_bf16_f32 v104, v104, v105
    v_cvt_pk_bf16_f32 v105, v106, v107
    ds_write_b64 v177, v[104:105] offset:10512
    v_cvt_pk_bf16_f32 v108, v108, v109
    v_cvt_pk_bf16_f32 v109, v110, v111
    ds_write_b64 v177, v[108:109] offset:10528
    v_cvt_pk_bf16_f32 v112, v112, v113
    v_cvt_pk_bf16_f32 v113, v114, v115
    ds_write_b64 v177, v[112:113] offset:10544
    v_cvt_pk_bf16_f32 v116, v116, v117
    v_cvt_pk_bf16_f32 v117, v118, v119
    ds_write_b64 v177, v[116:117] offset:10624
    v_cvt_pk_bf16_f32 v120, v120, v121
    v_cvt_pk_bf16_f32 v121, v122, v123
    ds_write_b64 v177, v[120:121] offset:10640
    v_cvt_pk_bf16_f32 v124, v124, v125
    v_cvt_pk_bf16_f32 v125, v126, v127
    ds_write_b64 v177, v[124:125] offset:10656
    v_cvt_pk_bf16_f32 v128, v128, v129
    v_cvt_pk_bf16_f32 v129, v130, v131
    ds_write_b64 v177, v[128:129] offset:10672
    s_mul_i32 s42, s45, 10496
    s_add_u32 s42, s42, 256
    v_add_u32 v177, s42, v176
    v_cvt_pk_bf16_f32 v8, v132, v133
    v_cvt_pk_bf16_f32 v9, v134, v135
    ds_write_b64 v177, v[8:9] offset:0
    v_cvt_pk_bf16_f32 v10, v136, v137
    v_cvt_pk_bf16_f32 v11, v138, v139
    ds_write_b64 v177, v[10:11] offset:16
    s_cmp_eq_u32 s13, 0
    s_cbranch_scc0 proj_notalpha
    v_mov_b32 v178, 1051597459
    v_mul_f32 v140, v140, v178
    v_mul_f32 v141, v141, v178
    v_mul_f32 v142, v142, v178
    v_mul_f32 v143, v143, v178
    v_mul_f32 v144, v144, v178
    v_mul_f32 v145, v145, v178
    v_mul_f32 v146, v146, v178
    v_mul_f32 v147, v147, v178
    v_cvt_pk_bf16_f32 v12, v140, v141
    v_cvt_pk_bf16_f32 v13, v142, v143
    v_cvt_pk_bf16_f32 v14, v144, v145
    v_cvt_pk_bf16_f32 v15, v146, v147
    v_and_b32 v179, 0x13, v1
    v_and_b32 v188, 4, v1
    v_lshlrev_b32 v188, 1, v188
    v_or_b32 v179, v179, v188
    v_and_b32 v188, 8, v1
    v_lshrrev_b32 v188, 1, v188
    v_or_b32 v179, v179, v188
    v_lshlrev_b32 v180, 5, v2
    v_add_u32 v179, v179, v180
    v_lshlrev_b32 v179, 4, v179
    s_mul_i32 s42, s46, 2432
    s_add_u32 s42, s42, 4718592
    buffer_store_dwordx4 v[12:15], v179, s[32:35], s42 offen sc1
    v_mov_b32 v181, 0
    s_nop 0
    v_dot2_f32_bf16 v181, v12, v12, v181
    s_nop 2
    v_dot2_f32_bf16 v181, v13, v13, v181
    s_nop 2
    v_dot2_f32_bf16 v181, v14, v14, v181
    s_nop 2
    v_dot2_f32_bf16 v181, v15, v15, v181
    s_nop 2
    v_mov_b32 v182, v181
    s_nop 1
    v_permlane32_swap_b32 v181, v182
    s_nop 1
    v_add_f32 v181, v181, v182
    s_nop 1
    v_max_f32_dpp v181, v181, v181 row_shr:1 row_mask:0xf bank_mask:0xf bound_ctrl:0
    s_nop 1
    v_max_f32_dpp v181, v181, v181 row_shr:2 row_mask:0xf bank_mask:0xf bound_ctrl:0
    s_nop 1
    v_max_f32_dpp v181, v181, v181 row_shr:4 row_mask:0xf bank_mask:0xf bound_ctrl:0
    s_nop 1
    v_max_f32_dpp v181, v181, v181 row_shr:8 row_mask:0xf bank_mask:0xf bound_ctrl:0
    s_nop 1
    v_max_f32_dpp v181, v181, v181 row_bcast:15 row_mask:0xa bank_mask:0xf
    s_nop 1
    v_max_f32_dpp v181, v181, v181 row_bcast:31 row_mask:0xc bank_mask:0xf
    v_mov_b32 v189, 2146435072
    v_mov_b32 v190, 0
    v_cmp_eq_u32 vcc, 63, v0
    s_nop 1
    v_cndmask_b32 v192, v189, v190, vcc
    v_mov_b32 v193, v181
    s_mov_b32 s42, 7208960
    s_add_u32 s42, s42, 21632 + 0
    buffer_atomic_umax v193, v192, s[32:35], s42 offen sc1
proj_notalpha:
    s_cmp_eq_u32 s13, 1
    s_cbranch_scc0 proj_notbeta
    v_mov_b32 v178, 1051597459
    v_mul_f32 v140, v140, v178
    v_mul_f32 v141, v141, v178
    v_cvt_pk_bf16_f32 v12, v140, v141
    v_and_b32 v179, 0x13, v1
    v_and_b32 v188, 4, v1
    v_lshlrev_b32 v188, 1, v188
    v_or_b32 v179, v179, v188
    v_and_b32 v188, 8, v1
    v_lshrrev_b32 v188, 1, v188
    v_or_b32 v179, v179, v188
    v_lshlrev_b32 v179, 2, v179
    v_mov_b32 v180, 2146435072
    v_cmp_eq_u32 vcc, 0, v2
    s_nop 1
    v_cndmask_b32 v179, v180, v179, vcc
    v_cndmask_b32 v12, 0, v12, vcc
    s_mul_i32 s42, s46, 2432
    s_add_u32 s42, s42, 4719616
    buffer_store_dword v12, v179, s[32:35], s42 offen sc1
    v_mov_b32 v181, 0
    s_nop 0
    v_dot2_f32_bf16 v181, v12, v12, v181
    s_nop 2
    s_nop 1
    v_max_f32_dpp v181, v181, v181 row_shr:1 row_mask:0xf bank_mask:0xf bound_ctrl:0
    s_nop 1
    v_max_f32_dpp v181, v181, v181 row_shr:2 row_mask:0xf bank_mask:0xf bound_ctrl:0
    s_nop 1
    v_max_f32_dpp v181, v181, v181 row_shr:4 row_mask:0xf bank_mask:0xf bound_ctrl:0
    s_nop 1
    v_max_f32_dpp v181, v181, v181 row_shr:8 row_mask:0xf bank_mask:0xf bound_ctrl:0
    s_nop 1
    v_max_f32_dpp v181, v181, v181 row_bcast:15 row_mask:0xa bank_mask:0xf
    s_nop 1
    v_max_f32_dpp v181, v181, v181 row_bcast:31 row_mask:0xc bank_mask:0xf
    v_mov_b32 v189, 2146435072
    v_mov_b32 v190, 0
    v_cmp_eq_u32 vcc, 63, v0
    s_nop 1
    v_cndmask_b32 v192, v189, v190, vcc
    v_mov_b32 v193, v181
    s_mov_b32 s42, 7208960
    s_add_u32 s42, s42, 21632 + 128
    buffer_atomic_umax v193, v192, s[32:35], s42 offen sc1
proj_notbeta:
    s_cmp_eq_u32 s13, 2
    s_cbranch_scc0 proj_qout
    v_add_f32 v181, v140, v145
    v_mul_f32 v181, 3216550459, v181
    v_exp_f32 v181, v181
    s_nop 0
    v_add_f32 v181, 1.0, v181
    v_rcp_f32 v181, v181
    v_lshlrev_b32 v179, 2, v1
    v_mov_b32 v180, 2146435072
    v_cmp_eq_u32 vcc, 0, v2
    s_nop 1
    v_cndmask_b32 v179, v180, v179, vcc
    s_lshl_b32 s42, s46, 7
    s_add_u32 s42, s42, 4915200
    buffer_store_dword v181, v179, s[32:35], s42 offen sc1
proj_qout:
    s_waitcnt lgkmcnt(0)
    s_barrier
    s_and_b32 s42, s14, 3
    s_lshr_b32 s43, s14, 2
    s_mul_i32 s44, s42, 10496
    s_mul_i32 s45, s43, 144
    s_add_u32 s44, s44, s45
    v_mul_u32_u24 v176, 328, v1
    v_lshlrev_b32 v177, 3, v2
    v_add_u32 v176, v176, v177
    v_add_u32 v176, s44, v176
    ds_read2_b32 v[8:9], v176 offset0:0 offset1:1
    ds_read2_b32 v[10:11], v176 offset0:4 offset1:5
    ds_read_b32 v12, v176 offset:32
    ds_read2_b32 v[14:15], v176 offset0:9 offset1:10
    ds_read2_b32 v[16:17], v176 offset0:13 offset1:14
    ds_read_b32 v18, v176 offset:68
    ds_read2_b32 v[20:21], v176 offset0:18 offset1:19
    ds_read2_b32 v[22:23], v176 offset0:22 offset1:23
    ds_read_b32 v24, v176 offset:104
    ds_read2_b32 v[26:27], v176 offset0:27 offset1:28
    ds_read2_b32 v[28:29], v176 offset0:31 offset1:32
    ds_read_b32 v30, v176 offset:140
    s_and_b32 s44, s13, 3
    s_lshl_b32 s44, s44, 3
    s_lshl_b32 s43, s43, 2
    s_add_u32 s44, s44, s43
    s_lshl_b32 s44, s44, 6
    s_lshl_b32 s45, s12, 2
    s_add_u32 s44, s44, s45
    s_add_u32 s44, s44, s42
    s_cmp_ge_u32 s13, 4
    s_cselect_b32 s46, 2097152, 0
    s_mov_b32 s47, 4194304
    s_cmov_b32 s47, 4456448
    s_lshl_b32 s42, s44, 10
    s_add_u32 s46, s46, s42
    s_lshl_b32 s42, s44, 7
    s_add_u32 s47, s47, s42
    v_lshlrev_b32 v178, 4, v0
    v_lshlrev_b32 v179, 2, v1
    v_mov_b32 v180, 2146435072
    v_cmp_eq_u32 vcc, 0, v2
    s_nop 1
    v_cndmask_b32 v179, v180, v179, vcc
    s_waitcnt lgkmcnt(9)
    buffer_store_dwordx4 v[8:11], v178, s[32:35], s46 offen sc1
    buffer_store_dword v12, v179, s[32:35], s47 offen sc1
    s_add_u32 s46, s46, 65536
    s_add_u32 s47, s47, 8192
    s_waitcnt lgkmcnt(6)
    buffer_store_dwordx4 v[14:17], v178, s[32:35], s46 offen sc1
    buffer_store_dword v18, v179, s[32:35], s47 offen sc1
    s_add_u32 s46, s46, 65536
    s_add_u32 s47, s47, 8192
    s_waitcnt lgkmcnt(3)
    buffer_store_dwordx4 v[20:23], v178, s[32:35], s46 offen sc1
    buffer_store_dword v24, v179, s[32:35], s47 offen sc1
    s_add_u32 s46, s46, 65536
    s_add_u32 s47, s47, 8192
    s_waitcnt lgkmcnt(0)
    buffer_store_dwordx4 v[26:29], v178, s[32:35], s46 offen sc1
    buffer_store_dword v30, v179, s[32:35], s47 offen sc1
    s_cmp_lt_u32 s13, 2
    s_cbranch_scc0 proj_fin
    s_cmp_lt_u32 s14, 4
    s_cbranch_scc0 proj_fin
    s_waitcnt vmcnt(8)
    v_mov_b32 v192, -1
    v_mov_b32 v190, 163832
    v_mov_b32 v191, 1
    s_mov_b32 exec_hi, 0
    s_mov_b32 exec_lo, 1
    ds_add_rtn_u32 v191, v190, v191
    s_mov_b64 exec, -1
    s_waitcnt lgkmcnt(0)
    v_readfirstlane_b32 s99, v191
    s_nop 3
    s_cmp_eq_u32 s99, 3
    s_cbranch_scc0 proj_is3
    v_mov_b32 v192, 1
    v_mov_b32 v190, 2146435072
    v_mov_b32 v191, 0
    v_cmp_eq_u32 vcc, 0, v0
    s_mov_b32 s99, 7230464
    s_nop 0
    v_cndmask_b32 v190, v190, v191, vcc
    buffer_atomic_add v192, v190, s[32:35], s99 offen sc0 sc1
proj_is3:
    s_waitcnt vmcnt(0)
    v_readfirstlane_b32 s99, v192
    s_nop 3
    s_cmp_eq_u32 s99, 63
    s_cbranch_scc0 proj_ic4
    v_lshlrev_b32 v190, 7, v0
    v_mov_b32 v191, 2146435072
    v_cmp_gt_u32 vcc, 32, v0
    v_mov_b32 v189, 1
    s_mov_b32 s99, 7254016
    v_cndmask_b32 v190, v191, v190, vcc
    buffer_store_dword v189, v190, s[32:35], s99 offen sc1
proj_ic4:
    s_branch proj_fin
proj_a_kv:
    s_cmp_eq_u32 s47, 0
    s_cbranch_scc0 proj_a_kv1
    s_waitcnt vmcnt(0)
    s_barrier
    ds_read_b128 v[8:11], v148 offset:0
    ds_read_b128 v[12:15], v148 offset:4096
    ds_read_b64_tr_b16 v[32:33], v152 offset:0
    ds_read_b64_tr_b16 v[34:35], v153 offset:1152
    ds_read_b64_tr_b16 v[36:37], v154 offset:0
    ds_read_b64_tr_b16 v[38:39], v155 offset:1152
    ds_read_b64_tr_b16 v[40:41], v160 offset:0
    ds_read_b64_tr_b16 v[42:43], v161 offset:0
    ds_read_b128 v[16:19], v149 offset:0
    ds_read_b128 v[20:23], v149 offset:4096
    ds_read_b64_tr_b16 v[44:45], v152 offset:4608
    ds_read_b64_tr_b16 v[46:47], v153 offset:5760
    ds_read_b64_tr_b16 v[48:49], v154 offset:4608
    ds_read_b64_tr_b16 v[50:51], v155 offset:5760
    ds_read_b64_tr_b16 v[52:53], v162 offset:0
    ds_read_b64_tr_b16 v[54:55], v163 offset:0
    s_waitcnt lgkmcnt(8)
    v_mfma_f32_32x32x16_bf16 v[68:83], v[8:11], v[32:35], v[68:83]
    ds_read_b128 v[24:27], v150 offset:0
    ds_read_b128 v[28:31], v150 offset:4096
    v_mfma_f32_32x32x16_bf16 v[84:99], v[8:11], v[36:39], v[84:99]
    ds_read_b64_tr_b16 v[56:57], v152 offset:9216
    ds_read_b64_tr_b16 v[58:59], v153 offset:10368
    v_mfma_f32_32x32x16_bf16 v[100:115], v[12:15], v[32:35], v[100:115]
    ds_read_b64_tr_b16 v[60:61], v154 offset:9216
    ds_read_b64_tr_b16 v[62:63], v155 offset:10368
    v_mfma_f32_32x32x16_bf16 v[116:131], v[12:15], v[36:39], v[116:131]
    ds_read_b64_tr_b16 v[64:65], v164 offset:0
    ds_read_b64_tr_b16 v[66:67], v165 offset:0
    v_mfma_f32_32x32x16_bf16 v[132:147], v[8:11], v[40:43], v[132:147]
    s_waitcnt lgkmcnt(8)
    v_mfma_f32_32x32x16_bf16 v[68:83], v[16:19], v[44:47], v[68:83]
    ds_read_b128 v[8:11], v151 offset:0
    ds_read_b128 v[12:15], v151 offset:4096
    v_mfma_f32_32x32x16_bf16 v[84:99], v[16:19], v[48:51], v[84:99]
    ds_read_b64_tr_b16 v[32:33], v152 offset:13824
    ds_read_b64_tr_b16 v[34:35], v153 offset:14976
    v_mfma_f32_32x32x16_bf16 v[100:115], v[20:23], v[44:47], v[100:115]
    ds_read_b64_tr_b16 v[36:37], v154 offset:13824
    ds_read_b64_tr_b16 v[38:39], v155 offset:14976
    v_mfma_f32_32x32x16_bf16 v[116:131], v[20:23], v[48:51], v[116:131]
    ds_read_b64_tr_b16 v[40:41], v166 offset:0
    ds_read_b64_tr_b16 v[42:43], v167 offset:0
    v_mfma_f32_32x32x16_bf16 v[132:147], v[16:19], v[52:55], v[132:147]
    s_waitcnt lgkmcnt(0)
    s_barrier
    v_mfma_f32_32x32x16_bf16 v[68:83], v[24:27], v[56:59], v[68:83]
    ds_read_b128 v[16:19], v148 offset:16384
    ds_read_b128 v[20:23], v148 offset:20480
    v_mfma_f32_32x32x16_bf16 v[84:99], v[24:27], v[60:63], v[84:99]
    ds_read_b64_tr_b16 v[44:45], v152 offset:20480
    ds_read_b64_tr_b16 v[46:47], v153 offset:21632
    v_mfma_f32_32x32x16_bf16 v[100:115], v[28:31], v[56:59], v[100:115]
    ds_read_b64_tr_b16 v[48:49], v154 offset:20480
    ds_read_b64_tr_b16 v[50:51], v155 offset:21632
    v_mfma_f32_32x32x16_bf16 v[116:131], v[28:31], v[60:63], v[116:131]
    ds_read_b64_tr_b16 v[52:53], v160 offset:20480
    ds_read_b64_tr_b16 v[54:55], v161 offset:20480
    v_mfma_f32_32x32x16_bf16 v[132:147], v[24:27], v[64:67], v[132:147]
    v_mfma_f32_32x32x16_bf16 v[68:83], v[8:11], v[32:35], v[68:83]
    ds_read_b128 v[24:27], v149 offset:16384
    ds_read_b128 v[28:31], v149 offset:20480
    v_mfma_f32_32x32x16_bf16 v[84:99], v[8:11], v[36:39], v[84:99]
    ds_read_b64_tr_b16 v[56:57], v152 offset:25088
    ds_read_b64_tr_b16 v[58:59], v153 offset:26240
    v_mfma_f32_32x32x16_bf16 v[100:115], v[12:15], v[32:35], v[100:115]
    ds_read_b64_tr_b16 v[60:61], v154 offset:25088
    ds_read_b64_tr_b16 v[62:63], v155 offset:26240
    v_mfma_f32_32x32x16_bf16 v[116:131], v[12:15], v[36:39], v[116:131]
    ds_read_b64_tr_b16 v[64:65], v162 offset:20480
    ds_read_b64_tr_b16 v[66:67], v163 offset:20480
    v_mfma_f32_32x32x16_bf16 v[132:147], v[8:11], v[40:43], v[132:147]
    s_waitcnt lgkmcnt(8)
    v_mfma_f32_32x32x16_bf16 v[68:83], v[16:19], v[44:47], v[68:83]
    ds_read_b128 v[8:11], v150 offset:16384
    ds_read_b128 v[12:15], v150 offset:20480
    v_mfma_f32_32x32x16_bf16 v[84:99], v[16:19], v[48:51], v[84:99]
    ds_read_b64_tr_b16 v[32:33], v152 offset:29696
    ds_read_b64_tr_b16 v[34:35], v153 offset:30848
    v_mfma_f32_32x32x16_bf16 v[100:115], v[20:23], v[44:47], v[100:115]
    ds_read_b64_tr_b16 v[36:37], v154 offset:29696
    ds_read_b64_tr_b16 v[38:39], v155 offset:30848
    v_mfma_f32_32x32x16_bf16 v[116:131], v[20:23], v[48:51], v[116:131]
    ds_read_b64_tr_b16 v[40:41], v164 offset:20480
    ds_read_b64_tr_b16 v[42:43], v165 offset:20480
    v_mfma_f32_32x32x16_bf16 v[132:147], v[16:19], v[52:55], v[132:147]
    s_waitcnt lgkmcnt(8)
    v_mfma_f32_32x32x16_bf16 v[68:83], v[24:27], v[56:59], v[68:83]
    ds_read_b128 v[16:19], v151 offset:16384
    ds_read_b128 v[20:23], v151 offset:20480
    v_mfma_f32_32x32x16_bf16 v[84:99], v[24:27], v[60:63], v[84:99]
    ds_read_b64_tr_b16 v[44:45], v152 offset:34304
    ds_read_b64_tr_b16 v[46:47], v153 offset:35456
    v_mfma_f32_32x32x16_bf16 v[100:115], v[28:31], v[56:59], v[100:115]
    ds_read_b64_tr_b16 v[48:49], v154 offset:34304
    ds_read_b64_tr_b16 v[50:51], v155 offset:35456
    v_mfma_f32_32x32x16_bf16 v[116:131], v[28:31], v[60:63], v[116:131]
    ds_read_b64_tr_b16 v[52:53], v166 offset:20480
    ds_read_b64_tr_b16 v[54:55], v167 offset:20480
    v_mfma_f32_32x32x16_bf16 v[132:147], v[24:27], v[64:67], v[132:147]
    s_waitcnt lgkmcnt(0)
    s_barrier
    v_mfma_f32_32x32x16_bf16 v[68:83], v[8:11], v[32:35], v[68:83]
    ds_read_b128 v[24:27], v148 offset:32768
    ds_read_b128 v[28:31], v148 offset:36864
    v_mfma_f32_32x32x16_bf16 v[84:99], v[8:11], v[36:39], v[84:99]
    ds_read_b64_tr_b16 v[56:57], v152 offset:40960
    ds_read_b64_tr_b16 v[58:59], v153 offset:42112
    v_mfma_f32_32x32x16_bf16 v[100:115], v[12:15], v[32:35], v[100:115]
    ds_read_b64_tr_b16 v[60:61], v154 offset:40960
    ds_read_b64_tr_b16 v[62:63], v155 offset:42112
    v_mfma_f32_32x32x16_bf16 v[116:131], v[12:15], v[36:39], v[116:131]
    ds_read_b64_tr_b16 v[64:65], v160 offset:40960
    ds_read_b64_tr_b16 v[66:67], v161 offset:40960
    v_mfma_f32_32x32x16_bf16 v[132:147], v[8:11], v[40:43], v[132:147]
    v_mfma_f32_32x32x16_bf16 v[68:83], v[16:19], v[44:47], v[68:83]
    ds_read_b128 v[8:11], v149 offset:32768
    ds_read_b128 v[12:15], v149 offset:36864
    v_mfma_f32_32x32x16_bf16 v[84:99], v[16:19], v[48:51], v[84:99]
    ds_read_b64_tr_b16 v[32:33], v152 offset:45568
    ds_read_b64_tr_b16 v[34:35], v153 offset:46720
    v_mfma_f32_32x32x16_bf16 v[100:115], v[20:23], v[44:47], v[100:115]
    ds_read_b64_tr_b16 v[36:37], v154 offset:45568
    ds_read_b64_tr_b16 v[38:39], v155 offset:46720
    v_mfma_f32_32x32x16_bf16 v[116:131], v[20:23], v[48:51], v[116:131]
    ds_read_b64_tr_b16 v[40:41], v162 offset:40960
    ds_read_b64_tr_b16 v[42:43], v163 offset:40960
    v_mfma_f32_32x32x16_bf16 v[132:147], v[16:19], v[52:55], v[132:147]
    s_waitcnt lgkmcnt(8)
    v_mfma_f32_32x32x16_bf16 v[68:83], v[24:27], v[56:59], v[68:83]
    ds_read_b128 v[16:19], v150 offset:32768
    ds_read_b128 v[20:23], v150 offset:36864
    v_mfma_f32_32x32x16_bf16 v[84:99], v[24:27], v[60:63], v[84:99]
    ds_read_b64_tr_b16 v[44:45], v152 offset:50176
    ds_read_b64_tr_b16 v[46:47], v153 offset:51328
    v_mfma_f32_32x32x16_bf16 v[100:115], v[28:31], v[56:59], v[100:115]
    ds_read_b64_tr_b16 v[48:49], v154 offset:50176
    ds_read_b64_tr_b16 v[50:51], v155 offset:51328
    v_mfma_f32_32x32x16_bf16 v[116:131], v[28:31], v[60:63], v[116:131]
    ds_read_b64_tr_b16 v[52:53], v164 offset:40960
    ds_read_b64_tr_b16 v[54:55], v165 offset:40960
    v_mfma_f32_32x32x16_bf16 v[132:147], v[24:27], v[64:67], v[132:147]
    s_waitcnt lgkmcnt(8)
    v_mfma_f32_32x32x16_bf16 v[68:83], v[8:11], v[32:35], v[68:83]
    ds_read_b128 v[24:27], v151 offset:32768
    ds_read_b128 v[28:31], v151 offset:36864
    v_mfma_f32_32x32x16_bf16 v[84:99], v[8:11], v[36:39], v[84:99]
    ds_read_b64_tr_b16 v[56:57], v152 offset:54784
    ds_read_b64_tr_b16 v[58:59], v153 offset:55936
    v_mfma_f32_32x32x16_bf16 v[100:115], v[12:15], v[32:35], v[100:115]
    ds_read_b64_tr_b16 v[60:61], v154 offset:54784
    ds_read_b64_tr_b16 v[62:63], v155 offset:55936
    v_mfma_f32_32x32x16_bf16 v[116:131], v[12:15], v[36:39], v[116:131]
    ds_read_b64_tr_b16 v[64:65], v166 offset:40960
    ds_read_b64_tr_b16 v[66:67], v167 offset:40960
    v_mfma_f32_32x32x16_bf16 v[132:147], v[8:11], v[40:43], v[132:147]
    s_waitcnt lgkmcnt(0)
    s_barrier
    v_mfma_f32_32x32x16_bf16 v[68:83], v[16:19], v[44:47], v[68:83]
    ds_read_b128 v[8:11], v148 offset:49152
    ds_read_b128 v[12:15], v148 offset:53248
    v_mfma_f32_32x32x16_bf16 v[84:99], v[16:19], v[48:51], v[84:99]
    ds_read_b64_tr_b16 v[32:33], v156 offset:0
    ds_read_b64_tr_b16 v[34:35], v157 offset:1152
    v_mfma_f32_32x32x16_bf16 v[100:115], v[20:23], v[44:47], v[100:115]
    ds_read_b64_tr_b16 v[36:37], v158 offset:0
    ds_read_b64_tr_b16 v[38:39], v159 offset:1152
    v_mfma_f32_32x32x16_bf16 v[116:131], v[20:23], v[48:51], v[116:131]
    ds_read_b64_tr_b16 v[40:41], v168 offset:0
    ds_read_b64_tr_b16 v[42:43], v169 offset:0
    v_mfma_f32_32x32x16_bf16 v[132:147], v[16:19], v[52:55], v[132:147]
    v_mfma_f32_32x32x16_bf16 v[68:83], v[24:27], v[56:59], v[68:83]
    ds_read_b128 v[16:19], v149 offset:49152
    ds_read_b128 v[20:23], v149 offset:53248
    v_mfma_f32_32x32x16_bf16 v[84:99], v[24:27], v[60:63], v[84:99]
    ds_read_b64_tr_b16 v[44:45], v156 offset:4608
    ds_read_b64_tr_b16 v[46:47], v157 offset:5760
    v_mfma_f32_32x32x16_bf16 v[100:115], v[28:31], v[56:59], v[100:115]
    ds_read_b64_tr_b16 v[48:49], v158 offset:4608
    ds_read_b64_tr_b16 v[50:51], v159 offset:5760
    v_mfma_f32_32x32x16_bf16 v[116:131], v[28:31], v[60:63], v[116:131]
    ds_read_b64_tr_b16 v[52:53], v170 offset:0
    ds_read_b64_tr_b16 v[54:55], v171 offset:0
    v_mfma_f32_32x32x16_bf16 v[132:147], v[24:27], v[64:67], v[132:147]
    s_waitcnt lgkmcnt(8)
    v_mfma_f32_32x32x16_bf16 v[68:83], v[8:11], v[32:35], v[68:83]
    ds_read_b128 v[24:27], v150 offset:49152
    ds_read_b128 v[28:31], v150 offset:53248
    v_mfma_f32_32x32x16_bf16 v[84:99], v[8:11], v[36:39], v[84:99]
    ds_read_b64_tr_b16 v[56:57], v156 offset:9216
    ds_read_b64_tr_b16 v[58:59], v157 offset:10368
    v_mfma_f32_32x32x16_bf16 v[100:115], v[12:15], v[32:35], v[100:115]
    ds_read_b64_tr_b16 v[60:61], v158 offset:9216
    ds_read_b64_tr_b16 v[62:63], v159 offset:10368
    v_mfma_f32_32x32x16_bf16 v[116:131], v[12:15], v[36:39], v[116:131]
    ds_read_b64_tr_b16 v[64:65], v172 offset:0
    ds_read_b64_tr_b16 v[66:67], v173 offset:0
    v_mfma_f32_32x32x16_bf16 v[132:147], v[8:11], v[40:43], v[132:147]
    s_waitcnt lgkmcnt(8)
    v_mfma_f32_32x32x16_bf16 v[68:83], v[16:19], v[44:47], v[68:83]
    ds_read_b128 v[8:11], v151 offset:49152
    ds_read_b128 v[12:15], v151 offset:53248
    v_mfma_f32_32x32x16_bf16 v[84:99], v[16:19], v[48:51], v[84:99]
    ds_read_b64_tr_b16 v[32:33], v156 offset:13824
    ds_read_b64_tr_b16 v[34:35], v157 offset:14976
    v_mfma_f32_32x32x16_bf16 v[100:115], v[20:23], v[44:47], v[100:115]
    ds_read_b64_tr_b16 v[36:37], v158 offset:13824
    ds_read_b64_tr_b16 v[38:39], v159 offset:14976
    v_mfma_f32_32x32x16_bf16 v[116:131], v[20:23], v[48:51], v[116:131]
    ds_read_b64_tr_b16 v[40:41], v174 offset:0
    ds_read_b64_tr_b16 v[42:43], v175 offset:0
    v_mfma_f32_32x32x16_bf16 v[132:147], v[16:19], v[52:55], v[132:147]
    s_waitcnt lgkmcnt(0)
    s_barrier
    v_mfma_f32_32x32x16_bf16 v[68:83], v[24:27], v[56:59], v[68:83]
    ds_read_b128 v[16:19], v148 offset:0
    ds_read_b128 v[20:23], v148 offset:4096
    v_mfma_f32_32x32x16_bf16 v[84:99], v[24:27], v[60:63], v[84:99]
    ds_read_b64_tr_b16 v[44:45], v152 offset:0
    ds_read_b64_tr_b16 v[46:47], v153 offset:1152
    v_mfma_f32_32x32x16_bf16 v[100:115], v[28:31], v[56:59], v[100:115]
    ds_read_b64_tr_b16 v[48:49], v154 offset:0
    ds_read_b64_tr_b16 v[50:51], v155 offset:1152
    v_mfma_f32_32x32x16_bf16 v[116:131], v[28:31], v[60:63], v[116:131]
    ds_read_b64_tr_b16 v[52:53], v160 offset:0
    ds_read_b64_tr_b16 v[54:55], v161 offset:0
    v_mfma_f32_32x32x16_bf16 v[132:147], v[24:27], v[64:67], v[132:147]
    v_mfma_f32_32x32x16_bf16 v[68:83], v[8:11], v[32:35], v[68:83]
    ds_read_b128 v[24:27], v149 offset:0
    ds_read_b128 v[28:31], v149 offset:4096
    v_mfma_f32_32x32x16_bf16 v[84:99], v[8:11], v[36:39], v[84:99]
    ds_read_b64_tr_b16 v[56:57], v152 offset:4608
    ds_read_b64_tr_b16 v[58:59], v153 offset:5760
    v_mfma_f32_32x32x16_bf16 v[100:115], v[12:15], v[32:35], v[100:115]
    ds_read_b64_tr_b16 v[60:61], v154 offset:4608
    ds_read_b64_tr_b16 v[62:63], v155 offset:5760
    v_mfma_f32_32x32x16_bf16 v[116:131], v[12:15], v[36:39], v[116:131]
    ds_read_b64_tr_b16 v[64:65], v162 offset:0
    ds_read_b64_tr_b16 v[66:67], v163 offset:0
    v_mfma_f32_32x32x16_bf16 v[132:147], v[8:11], v[40:43], v[132:147]
    s_waitcnt lgkmcnt(8)
    v_mfma_f32_32x32x16_bf16 v[68:83], v[16:19], v[44:47], v[68:83]
    ds_read_b128 v[8:11], v150 offset:0
    ds_read_b128 v[12:15], v150 offset:4096
    v_mfma_f32_32x32x16_bf16 v[84:99], v[16:19], v[48:51], v[84:99]
    ds_read_b64_tr_b16 v[32:33], v152 offset:9216
    ds_read_b64_tr_b16 v[34:35], v153 offset:10368
    v_mfma_f32_32x32x16_bf16 v[100:115], v[20:23], v[44:47], v[100:115]
    ds_read_b64_tr_b16 v[36:37], v154 offset:9216
    ds_read_b64_tr_b16 v[38:39], v155 offset:10368
    v_mfma_f32_32x32x16_bf16 v[116:131], v[20:23], v[48:51], v[116:131]
    ds_read_b64_tr_b16 v[40:41], v164 offset:0
    ds_read_b64_tr_b16 v[42:43], v165 offset:0
    v_mfma_f32_32x32x16_bf16 v[132:147], v[16:19], v[52:55], v[132:147]
    s_waitcnt lgkmcnt(8)
    v_mfma_f32_32x32x16_bf16 v[68:83], v[24:27], v[56:59], v[68:83]
    ds_read_b128 v[16:19], v151 offset:0
    ds_read_b128 v[20:23], v151 offset:4096
    v_mfma_f32_32x32x16_bf16 v[84:99], v[24:27], v[60:63], v[84:99]
    ds_read_b64_tr_b16 v[44:45], v152 offset:13824
    ds_read_b64_tr_b16 v[46:47], v153 offset:14976
    v_mfma_f32_32x32x16_bf16 v[100:115], v[28:31], v[56:59], v[100:115]
    ds_read_b64_tr_b16 v[48:49], v154 offset:13824
    ds_read_b64_tr_b16 v[50:51], v155 offset:14976
    v_mfma_f32_32x32x16_bf16 v[116:131], v[28:31], v[60:63], v[116:131]
    ds_read_b64_tr_b16 v[52:53], v166 offset:0
    ds_read_b64_tr_b16 v[54:55], v167 offset:0
    v_mfma_f32_32x32x16_bf16 v[132:147], v[24:27], v[64:67], v[132:147]
    s_waitcnt lgkmcnt(0)
    s_barrier
    v_mfma_f32_32x32x16_bf16 v[68:83], v[8:11], v[32:35], v[68:83]
    ds_read_b128 v[24:27], v148 offset:16384
    ds_read_b128 v[28:31], v148 offset:20480
    v_mfma_f32_32x32x16_bf16 v[84:99], v[8:11], v[36:39], v[84:99]
    ds_read_b64_tr_b16 v[56:57], v152 offset:20480
    ds_read_b64_tr_b16 v[58:59], v153 offset:21632
    v_mfma_f32_32x32x16_bf16 v[100:115], v[12:15], v[32:35], v[100:115]
    ds_read_b64_tr_b16 v[60:61], v154 offset:20480
    ds_read_b64_tr_b16 v[62:63], v155 offset:21632
    v_mfma_f32_32x32x16_bf16 v[116:131], v[12:15], v[36:39], v[116:131]
    ds_read_b64_tr_b16 v[64:65], v160 offset:20480
    ds_read_b64_tr_b16 v[66:67], v161 offset:20480
    v_mfma_f32_32x32x16_bf16 v[132:147], v[8:11], v[40:43], v[132:147]
    v_mfma_f32_32x32x16_bf16 v[68:83], v[16:19], v[44:47], v[68:83]
    ds_read_b128 v[8:11], v149 offset:16384
    ds_read_b128 v[12:15], v149 offset:20480
    v_mfma_f32_32x32x16_bf16 v[84:99], v[16:19], v[48:51], v[84:99]
    ds_read_b64_tr_b16 v[32:33], v152 offset:25088
    ds_read_b64_tr_b16 v[34:35], v153 offset:26240
    v_mfma_f32_32x32x16_bf16 v[100:115], v[20:23], v[44:47], v[100:115]
    ds_read_b64_tr_b16 v[36:37], v154 offset:25088
    ds_read_b64_tr_b16 v[38:39], v155 offset:26240
    v_mfma_f32_32x32x16_bf16 v[116:131], v[20:23], v[48:51], v[116:131]
    ds_read_b64_tr_b16 v[40:41], v162 offset:20480
    ds_read_b64_tr_b16 v[42:43], v163 offset:20480
    v_mfma_f32_32x32x16_bf16 v[132:147], v[16:19], v[52:55], v[132:147]
    s_waitcnt lgkmcnt(8)
    v_mfma_f32_32x32x16_bf16 v[68:83], v[24:27], v[56:59], v[68:83]
    ds_read_b128 v[16:19], v150 offset:16384
    ds_read_b128 v[20:23], v150 offset:20480
    v_mfma_f32_32x32x16_bf16 v[84:99], v[24:27], v[60:63], v[84:99]
    ds_read_b64_tr_b16 v[44:45], v152 offset:29696
    ds_read_b64_tr_b16 v[46:47], v153 offset:30848
    v_mfma_f32_32x32x16_bf16 v[100:115], v[28:31], v[56:59], v[100:115]
    ds_read_b64_tr_b16 v[48:49], v154 offset:29696
    ds_read_b64_tr_b16 v[50:51], v155 offset:30848
    v_mfma_f32_32x32x16_bf16 v[116:131], v[28:31], v[60:63], v[116:131]
    ds_read_b64_tr_b16 v[52:53], v164 offset:20480
    ds_read_b64_tr_b16 v[54:55], v165 offset:20480
    v_mfma_f32_32x32x16_bf16 v[132:147], v[24:27], v[64:67], v[132:147]
    s_waitcnt lgkmcnt(8)
    v_mfma_f32_32x32x16_bf16 v[68:83], v[8:11], v[32:35], v[68:83]
    ds_read_b128 v[24:27], v151 offset:16384
    ds_read_b128 v[28:31], v151 offset:20480
    v_mfma_f32_32x32x16_bf16 v[84:99], v[8:11], v[36:39], v[84:99]
    ds_read_b64_tr_b16 v[56:57], v152 offset:34304
    ds_read_b64_tr_b16 v[58:59], v153 offset:35456
    v_mfma_f32_32x32x16_bf16 v[100:115], v[12:15], v[32:35], v[100:115]
    ds_read_b64_tr_b16 v[60:61], v154 offset:34304
    ds_read_b64_tr_b16 v[62:63], v155 offset:35456
    v_mfma_f32_32x32x16_bf16 v[116:131], v[12:15], v[36:39], v[116:131]
    ds_read_b64_tr_b16 v[64:65], v166 offset:20480
    ds_read_b64_tr_b16 v[66:67], v167 offset:20480
    v_mfma_f32_32x32x16_bf16 v[132:147], v[8:11], v[40:43], v[132:147]
    s_waitcnt lgkmcnt(0)
    s_barrier
    v_mfma_f32_32x32x16_bf16 v[68:83], v[16:19], v[44:47], v[68:83]
    ds_read_b128 v[8:11], v148 offset:32768
    ds_read_b128 v[12:15], v148 offset:36864
    v_mfma_f32_32x32x16_bf16 v[84:99], v[16:19], v[48:51], v[84:99]
    ds_read_b64_tr_b16 v[32:33], v152 offset:40960
    ds_read_b64_tr_b16 v[34:35], v153 offset:42112
    v_mfma_f32_32x32x16_bf16 v[100:115], v[20:23], v[44:47], v[100:115]
    ds_read_b64_tr_b16 v[36:37], v154 offset:40960
    ds_read_b64_tr_b16 v[38:39], v155 offset:42112
    v_mfma_f32_32x32x16_bf16 v[116:131], v[20:23], v[48:51], v[116:131]
    ds_read_b64_tr_b16 v[40:41], v160 offset:40960
    ds_read_b64_tr_b16 v[42:43], v161 offset:40960
    v_mfma_f32_32x32x16_bf16 v[132:147], v[16:19], v[52:55], v[132:147]
    v_mfma_f32_32x32x16_bf16 v[68:83], v[24:27], v[56:59], v[68:83]
    ds_read_b128 v[16:19], v149 offset:32768
    ds_read_b128 v[20:23], v149 offset:36864
    v_mfma_f32_32x32x16_bf16 v[84:99], v[24:27], v[60:63], v[84:99]
    ds_read_b64_tr_b16 v[44:45], v152 offset:45568
    ds_read_b64_tr_b16 v[46:47], v153 offset:46720
    v_mfma_f32_32x32x16_bf16 v[100:115], v[28:31], v[56:59], v[100:115]
    ds_read_b64_tr_b16 v[48:49], v154 offset:45568
    ds_read_b64_tr_b16 v[50:51], v155 offset:46720
    v_mfma_f32_32x32x16_bf16 v[116:131], v[28:31], v[60:63], v[116:131]
    ds_read_b64_tr_b16 v[52:53], v162 offset:40960
    ds_read_b64_tr_b16 v[54:55], v163 offset:40960
    v_mfma_f32_32x32x16_bf16 v[132:147], v[24:27], v[64:67], v[132:147]
    s_waitcnt lgkmcnt(8)
    buffer_load_dword v194, v195, s[28:31], 0 offen sc1
    v_mfma_f32_32x32x16_bf16 v[68:83], v[8:11], v[32:35], v[68:83]
    ds_read_b128 v[24:27], v150 offset:32768
    ds_read_b128 v[28:31], v150 offset:36864
    v_mfma_f32_32x32x16_bf16 v[84:99], v[8:11], v[36:39], v[84:99]
    ds_read_b64_tr_b16 v[56:57], v152 offset:50176
    ds_read_b64_tr_b16 v[58:59], v153 offset:51328
    v_mfma_f32_32x32x16_bf16 v[100:115], v[12:15], v[32:35], v[100:115]
    ds_read_b64_tr_b16 v[60:61], v154 offset:50176
    ds_read_b64_tr_b16 v[62:63], v155 offset:51328
    v_mfma_f32_32x32x16_bf16 v[116:131], v[12:15], v[36:39], v[116:131]
    ds_read_b64_tr_b16 v[64:65], v164 offset:40960
    ds_read_b64_tr_b16 v[66:67], v165 offset:40960
    v_mfma_f32_32x32x16_bf16 v[132:147], v[8:11], v[40:43], v[132:147]
    s_waitcnt lgkmcnt(8)
    v_mfma_f32_32x32x16_bf16 v[68:83], v[16:19], v[44:47], v[68:83]
    ds_read_b128 v[8:11], v151 offset:32768
    ds_read_b128 v[12:15], v151 offset:36864
    v_mfma_f32_32x32x16_bf16 v[84:99], v[16:19], v[48:51], v[84:99]
    ds_read_b64_tr_b16 v[32:33], v152 offset:54784
    ds_read_b64_tr_b16 v[34:35], v153 offset:55936
    v_mfma_f32_32x32x16_bf16 v[100:115], v[20:23], v[44:47], v[100:115]
    ds_read_b64_tr_b16 v[36:37], v154 offset:54784
    ds_read_b64_tr_b16 v[38:39], v155 offset:55936
    v_mfma_f32_32x32x16_bf16 v[116:131], v[20:23], v[48:51], v[116:131]
    ds_read_b64_tr_b16 v[40:41], v166 offset:40960
    ds_read_b64_tr_b16 v[42:43], v167 offset:40960
    v_mfma_f32_32x32x16_bf16 v[132:147], v[16:19], v[52:55], v[132:147]
    s_waitcnt lgkmcnt(0)
    s_barrier
    v_mfma_f32_32x32x16_bf16 v[68:83], v[24:27], v[56:59], v[68:83]
    ds_read_b128 v[16:19], v148 offset:49152
    ds_read_b128 v[20:23], v148 offset:53248
    v_mfma_f32_32x32x16_bf16 v[84:99], v[24:27], v[60:63], v[84:99]
    ds_read_b64_tr_b16 v[44:45], v156 offset:0
    ds_read_b64_tr_b16 v[46:47], v157 offset:1152
    v_mfma_f32_32x32x16_bf16 v[100:115], v[28:31], v[56:59], v[100:115]
    ds_read_b64_tr_b16 v[48:49], v158 offset:0
    ds_read_b64_tr_b16 v[50:51], v159 offset:1152
    v_mfma_f32_32x32x16_bf16 v[116:131], v[28:31], v[60:63], v[116:131]
    ds_read_b64_tr_b16 v[52:53], v168 offset:0
    ds_read_b64_tr_b16 v[54:55], v169 offset:0
    v_mfma_f32_32x32x16_bf16 v[132:147], v[24:27], v[64:67], v[132:147]
    v_mfma_f32_32x32x16_bf16 v[68:83], v[8:11], v[32:35], v[68:83]
    ds_read_b128 v[24:27], v149 offset:49152
    ds_read_b128 v[28:31], v149 offset:53248
    v_mfma_f32_32x32x16_bf16 v[84:99], v[8:11], v[36:39], v[84:99]
    ds_read_b64_tr_b16 v[56:57], v156 offset:4608
    ds_read_b64_tr_b16 v[58:59], v157 offset:5760
    v_mfma_f32_32x32x16_bf16 v[100:115], v[12:15], v[32:35], v[100:115]
    ds_read_b64_tr_b16 v[60:61], v158 offset:4608
    ds_read_b64_tr_b16 v[62:63], v159 offset:5760
    v_mfma_f32_32x32x16_bf16 v[116:131], v[12:15], v[36:39], v[116:131]
    ds_read_b64_tr_b16 v[64:65], v170 offset:0
    ds_read_b64_tr_b16 v[66:67], v171 offset:0
    v_mfma_f32_32x32x16_bf16 v[132:147], v[8:11], v[40:43], v[132:147]
    s_waitcnt lgkmcnt(8)
    v_mfma_f32_32x32x16_bf16 v[68:83], v[16:19], v[44:47], v[68:83]
    ds_read_b128 v[8:11], v150 offset:49152
    ds_read_b128 v[12:15], v150 offset:53248
    v_mfma_f32_32x32x16_bf16 v[84:99], v[16:19], v[48:51], v[84:99]
    ds_read_b64_tr_b16 v[32:33], v156 offset:9216
    ds_read_b64_tr_b16 v[34:35], v157 offset:10368
    v_mfma_f32_32x32x16_bf16 v[100:115], v[20:23], v[44:47], v[100:115]
    ds_read_b64_tr_b16 v[36:37], v158 offset:9216
    ds_read_b64_tr_b16 v[38:39], v159 offset:10368
    v_mfma_f32_32x32x16_bf16 v[116:131], v[20:23], v[48:51], v[116:131]
    ds_read_b64_tr_b16 v[40:41], v172 offset:0
    ds_read_b64_tr_b16 v[42:43], v173 offset:0
    v_mfma_f32_32x32x16_bf16 v[132:147], v[16:19], v[52:55], v[132:147]
    s_waitcnt lgkmcnt(8)
    v_mfma_f32_32x32x16_bf16 v[68:83], v[24:27], v[56:59], v[68:83]
    ds_read_b128 v[16:19], v151 offset:49152
    ds_read_b128 v[20:23], v151 offset:53248
    v_mfma_f32_32x32x16_bf16 v[84:99], v[24:27], v[60:63], v[84:99]
    ds_read_b64_tr_b16 v[44:45], v156 offset:13824
    ds_read_b64_tr_b16 v[46:47], v157 offset:14976
    v_mfma_f32_32x32x16_bf16 v[100:115], v[28:31], v[56:59], v[100:115]
    ds_read_b64_tr_b16 v[48:49], v158 offset:13824
    ds_read_b64_tr_b16 v[50:51], v159 offset:14976
    v_mfma_f32_32x32x16_bf16 v[116:131], v[28:31], v[60:63], v[116:131]
    ds_read_b64_tr_b16 v[52:53], v174 offset:0
    ds_read_b64_tr_b16 v[54:55], v175 offset:0
    v_mfma_f32_32x32x16_bf16 v[132:147], v[24:27], v[64:67], v[132:147]
    s_waitcnt lgkmcnt(0)
    s_barrier
    v_mfma_f32_32x32x16_bf16 v[68:83], v[8:11], v[32:35], v[68:83]
    ds_read_b128 v[24:27], v148 offset:0
    ds_read_b128 v[28:31], v148 offset:4096
    v_mfma_f32_32x32x16_bf16 v[84:99], v[8:11], v[36:39], v[84:99]
    ds_read_b64_tr_b16 v[56:57], v152 offset:0
    ds_read_b64_tr_b16 v[58:59], v153 offset:1152
    v_mfma_f32_32x32x16_bf16 v[100:115], v[12:15], v[32:35], v[100:115]
    ds_read_b64_tr_b16 v[60:61], v154 offset:0
    ds_read_b64_tr_b16 v[62:63], v155 offset:1152
    v_mfma_f32_32x32x16_bf16 v[116:131], v[12:15], v[36:39], v[116:131]
    ds_read_b64_tr_b16 v[64:65], v160 offset:0
    ds_read_b64_tr_b16 v[66:67], v161 offset:0
    v_mfma_f32_32x32x16_bf16 v[132:147], v[8:11], v[40:43], v[132:147]
    v_mfma_f32_32x32x16_bf16 v[68:83], v[16:19], v[44:47], v[68:83]
    ds_read_b128 v[8:11], v149 offset:0
    ds_read_b128 v[12:15], v149 offset:4096
    v_mfma_f32_32x32x16_bf16 v[84:99], v[16:19], v[48:51], v[84:99]
    ds_read_b64_tr_b16 v[32:33], v152 offset:4608
    ds_read_b64_tr_b16 v[34:35], v153 offset:5760
    v_mfma_f32_32x32x16_bf16 v[100:115], v[20:23], v[44:47], v[100:115]
    ds_read_b64_tr_b16 v[36:37], v154 offset:4608
    ds_read_b64_tr_b16 v[38:39], v155 offset:5760
    v_mfma_f32_32x32x16_bf16 v[116:131], v[20:23], v[48:51], v[116:131]
    ds_read_b64_tr_b16 v[40:41], v162 offset:0
    ds_read_b64_tr_b16 v[42:43], v163 offset:0
    v_mfma_f32_32x32x16_bf16 v[132:147], v[16:19], v[52:55], v[132:147]
    s_waitcnt lgkmcnt(8)
    v_mfma_f32_32x32x16_bf16 v[68:83], v[24:27], v[56:59], v[68:83]
    ds_read_b128 v[16:19], v150 offset:0
    ds_read_b128 v[20:23], v150 offset:4096
    v_mfma_f32_32x32x16_bf16 v[84:99], v[24:27], v[60:63], v[84:99]
    ds_read_b64_tr_b16 v[44:45], v152 offset:9216
    ds_read_b64_tr_b16 v[46:47], v153 offset:10368
    v_mfma_f32_32x32x16_bf16 v[100:115], v[28:31], v[56:59], v[100:115]
    ds_read_b64_tr_b16 v[48:49], v154 offset:9216
    ds_read_b64_tr_b16 v[50:51], v155 offset:10368
    v_mfma_f32_32x32x16_bf16 v[116:131], v[28:31], v[60:63], v[116:131]
    ds_read_b64_tr_b16 v[52:53], v164 offset:0
    ds_read_b64_tr_b16 v[54:55], v165 offset:0
    v_mfma_f32_32x32x16_bf16 v[132:147], v[24:27], v[64:67], v[132:147]
    s_waitcnt lgkmcnt(8)
    v_mfma_f32_32x32x16_bf16 v[68:83], v[8:11], v[32:35], v[68:83]
    ds_read_b128 v[24:27], v151 offset:0
    ds_read_b128 v[28:31], v151 offset:4096
    v_mfma_f32_32x32x16_bf16 v[84:99], v[8:11], v[36:39], v[84:99]
    ds_read_b64_tr_b16 v[56:57], v152 offset:13824
    ds_read_b64_tr_b16 v[58:59], v153 offset:14976
    v_mfma_f32_32x32x16_bf16 v[100:115], v[12:15], v[32:35], v[100:115]
    ds_read_b64_tr_b16 v[60:61], v154 offset:13824
    ds_read_b64_tr_b16 v[62:63], v155 offset:14976
    v_mfma_f32_32x32x16_bf16 v[116:131], v[12:15], v[36:39], v[116:131]
    ds_read_b64_tr_b16 v[64:65], v166 offset:0
    ds_read_b64_tr_b16 v[66:67], v167 offset:0
    v_mfma_f32_32x32x16_bf16 v[132:147], v[8:11], v[40:43], v[132:147]
    s_waitcnt lgkmcnt(0)
    s_barrier
    v_mfma_f32_32x32x16_bf16 v[68:83], v[16:19], v[44:47], v[68:83]
    v_mfma_f32_32x32x16_bf16 v[84:99], v[16:19], v[48:51], v[84:99]
    v_mfma_f32_32x32x16_bf16 v[100:115], v[20:23], v[44:47], v[100:115]
    v_mfma_f32_32x32x16_bf16 v[116:131], v[20:23], v[48:51], v[116:131]
    v_mfma_f32_32x32x16_bf16 v[132:147], v[16:19], v[52:55], v[132:147]
    v_mfma_f32_32x32x16_bf16 v[68:83], v[24:27], v[56:59], v[68:83]
    v_mfma_f32_32x32x16_bf16 v[84:99], v[24:27], v[60:63], v[84:99]
    v_mfma_f32_32x32x16_bf16 v[100:115], v[28:31], v[56:59], v[100:115]
    v_mfma_f32_32x32x16_bf16 v[116:131], v[28:31], v[60:63], v[116:131]
    v_mfma_f32_32x32x16_bf16 v[132:147], v[24:27], v[64:67], v[132:147]
    s_branch proj_a_kvepi
proj_a_kv1:
    s_waitcnt vmcnt(0)
    s_barrier
    ds_read_b128 v[8:11], v148 offset:0
    ds_read_b128 v[12:15], v148 offset:4096
    ds_read_b64_tr_b16 v[32:33], v152 offset:0
    ds_read_b64_tr_b16 v[34:35], v153 offset:1152
    ds_read_b64_tr_b16 v[36:37], v154 offset:0
    ds_read_b64_tr_b16 v[38:39], v155 offset:1152
    ds_read_b64_tr_b16 v[40:41], v160 offset:0
    ds_read_b64_tr_b16 v[42:43], v161 offset:0
    ds_read_b128 v[16:19], v149 offset:0
    ds_read_b128 v[20:23], v149 offset:4096
    ds_read_b64_tr_b16 v[44:45], v152 offset:4608
    ds_read_b64_tr_b16 v[46:47], v153 offset:5760
    ds_read_b64_tr_b16 v[48:49], v154 offset:4608
    ds_read_b64_tr_b16 v[50:51], v155 offset:5760
    ds_read_b64_tr_b16 v[52:53], v162 offset:0
    ds_read_b64_tr_b16 v[54:55], v163 offset:0
    s_waitcnt lgkmcnt(8)
    v_mfma_f32_32x32x16_bf16 v[68:83], v[8:11], v[32:35], v[68:83]
    ds_read_b128 v[24:27], v150 offset:0
    ds_read_b128 v[28:31], v150 offset:4096
    v_mfma_f32_32x32x16_bf16 v[84:99], v[8:11], v[36:39], v[84:99]
    ds_read_b64_tr_b16 v[56:57], v152 offset:9216
    ds_read_b64_tr_b16 v[58:59], v153 offset:10368
    v_mfma_f32_32x32x16_bf16 v[100:115], v[12:15], v[32:35], v[100:115]
    ds_read_b64_tr_b16 v[60:61], v154 offset:9216
    ds_read_b64_tr_b16 v[62:63], v155 offset:10368
    v_mfma_f32_32x32x16_bf16 v[116:131], v[12:15], v[36:39], v[116:131]
    ds_read_b64_tr_b16 v[64:65], v164 offset:0
    ds_read_b64_tr_b16 v[66:67], v165 offset:0
    v_mfma_f32_32x32x16_bf16 v[132:147], v[12:15], v[40:43], v[132:147]
    s_waitcnt lgkmcnt(8)
    v_mfma_f32_32x32x16_bf16 v[68:83], v[16:19], v[44:47], v[68:83]
    ds_read_b128 v[8:11], v151 offset:0
    ds_read_b128 v[12:15], v151 offset:4096
    v_mfma_f32_32x32x16_bf16 v[84:99], v[16:19], v[48:51], v[84:99]
    ds_read_b64_tr_b16 v[32:33], v152 offset:13824
    ds_read_b64_tr_b16 v[34:35], v153 offset:14976
    v_mfma_f32_32x32x16_bf16 v[100:115], v[20:23], v[44:47], v[100:115]
    ds_read_b64_tr_b16 v[36:37], v154 offset:13824
    ds_read_b64_tr_b16 v[38:39], v155 offset:14976
    v_mfma_f32_32x32x16_bf16 v[116:131], v[20:23], v[48:51], v[116:131]
    ds_read_b64_tr_b16 v[40:41], v166 offset:0
    ds_read_b64_tr_b16 v[42:43], v167 offset:0
    v_mfma_f32_32x32x16_bf16 v[132:147], v[20:23], v[52:55], v[132:147]
    s_waitcnt lgkmcnt(0)
    s_barrier
    v_mfma_f32_32x32x16_bf16 v[68:83], v[24:27], v[56:59], v[68:83]
    ds_read_b128 v[16:19], v148 offset:16384
    ds_read_b128 v[20:23], v148 offset:20480
    v_mfma_f32_32x32x16_bf16 v[84:99], v[24:27], v[60:63], v[84:99]
    ds_read_b64_tr_b16 v[44:45], v152 offset:20480
    ds_read_b64_tr_b16 v[46:47], v153 offset:21632
    v_mfma_f32_32x32x16_bf16 v[100:115], v[28:31], v[56:59], v[100:115]
    ds_read_b64_tr_b16 v[48:49], v154 offset:20480
    ds_read_b64_tr_b16 v[50:51], v155 offset:21632
    v_mfma_f32_32x32x16_bf16 v[116:131], v[28:31], v[60:63], v[116:131]
    ds_read_b64_tr_b16 v[52:53], v160 offset:20480
    ds_read_b64_tr_b16 v[54:55], v161 offset:20480
    v_mfma_f32_32x32x16_bf16 v[132:147], v[28:31], v[64:67], v[132:147]
    v_mfma_f32_32x32x16_bf16 v[68:83], v[8:11], v[32:35], v[68:83]
    ds_read_b128 v[24:27], v149 offset:16384
    ds_read_b128 v[28:31], v149 offset:20480
    v_mfma_f32_32x32x16_bf16 v[84:99], v[8:11], v[36:39], v[84:99]
    ds_read_b64_tr_b16 v[56:57], v152 offset:25088
    ds_read_b64_tr_b16 v[58:59], v153 offset:26240
    v_mfma_f32_32x32x16_bf16 v[100:115], v[12:15], v[32:35], v[100:115]
    ds_read_b64_tr_b16 v[60:61], v154 offset:25088
    ds_read_b64_tr_b16 v[62:63], v155 offset:26240
    v_mfma_f32_32x32x16_bf16 v[116:131], v[12:15], v[36:39], v[116:131]
    ds_read_b64_tr_b16 v[64:65], v162 offset:20480
    ds_read_b64_tr_b16 v[66:67], v163 offset:20480
    v_mfma_f32_32x32x16_bf16 v[132:147], v[12:15], v[40:43], v[132:147]
    s_waitcnt lgkmcnt(8)
    v_mfma_f32_32x32x16_bf16 v[68:83], v[16:19], v[44:47], v[68:83]
    ds_read_b128 v[8:11], v150 offset:16384
    ds_read_b128 v[12:15], v150 offset:20480
    v_mfma_f32_32x32x16_bf16 v[84:99], v[16:19], v[48:51], v[84:99]
    ds_read_b64_tr_b16 v[32:33], v152 offset:29696
    ds_read_b64_tr_b16 v[34:35], v153 offset:30848
    v_mfma_f32_32x32x16_bf16 v[100:115], v[20:23], v[44:47], v[100:115]
    ds_read_b64_tr_b16 v[36:37], v154 offset:29696
    ds_read_b64_tr_b16 v[38:39], v155 offset:30848
    v_mfma_f32_32x32x16_bf16 v[116:131], v[20:23], v[48:51], v[116:131]
    ds_read_b64_tr_b16 v[40:41], v164 offset:20480
    ds_read_b64_tr_b16 v[42:43], v165 offset:20480
    v_mfma_f32_32x32x16_bf16 v[132:147], v[20:23], v[52:55], v[132:147]
    s_waitcnt lgkmcnt(8)
    v_mfma_f32_32x32x16_bf16 v[68:83], v[24:27], v[56:59], v[68:83]
    ds_read_b128 v[16:19], v151 offset:16384
    ds_read_b128 v[20:23], v151 offset:20480
    v_mfma_f32_32x32x16_bf16 v[84:99], v[24:27], v[60:63], v[84:99]
    ds_read_b64_tr_b16 v[44:45], v152 offset:34304
    ds_read_b64_tr_b16 v[46:47], v153 offset:35456
    v_mfma_f32_32x32x16_bf16 v[100:115], v[28:31], v[56:59], v[100:115]
    ds_read_b64_tr_b16 v[48:49], v154 offset:34304
    ds_read_b64_tr_b16 v[50:51], v155 offset:35456
    v_mfma_f32_32x32x16_bf16 v[116:131], v[28:31], v[60:63], v[116:131]
    ds_read_b64_tr_b16 v[52:53], v166 offset:20480
    ds_read_b64_tr_b16 v[54:55], v167 offset:20480
    v_mfma_f32_32x32x16_bf16 v[132:147], v[28:31], v[64:67], v[132:147]
    s_waitcnt lgkmcnt(0)
    s_barrier
    v_mfma_f32_32x32x16_bf16 v[68:83], v[8:11], v[32:35], v[68:83]
    ds_read_b128 v[24:27], v148 offset:32768
    ds_read_b128 v[28:31], v148 offset:36864
    v_mfma_f32_32x32x16_bf16 v[84:99], v[8:11], v[36:39], v[84:99]
    ds_read_b64_tr_b16 v[56:57], v152 offset:40960
    ds_read_b64_tr_b16 v[58:59], v153 offset:42112
    v_mfma_f32_32x32x16_bf16 v[100:115], v[12:15], v[32:35], v[100:115]
    ds_read_b64_tr_b16 v[60:61], v154 offset:40960
    ds_read_b64_tr_b16 v[62:63], v155 offset:42112
    v_mfma_f32_32x32x16_bf16 v[116:131], v[12:15], v[36:39], v[116:131]
    ds_read_b64_tr_b16 v[64:65], v160 offset:40960
    ds_read_b64_tr_b16 v[66:67], v161 offset:40960
    v_mfma_f32_32x32x16_bf16 v[132:147], v[12:15], v[40:43], v[132:147]
    v_mfma_f32_32x32x16_bf16 v[68:83], v[16:19], v[44:47], v[68:83]
    ds_read_b128 v[8:11], v149 offset:32768
    ds_read_b128 v[12:15], v149 offset:36864
    v_mfma_f32_32x32x16_bf16 v[84:99], v[16:19], v[48:51], v[84:99]
    ds_read_b64_tr_b16 v[32:33], v152 offset:45568
    ds_read_b64_tr_b16 v[34:35], v153 offset:46720
    v_mfma_f32_32x32x16_bf16 v[100:115], v[20:23], v[44:47], v[100:115]
    ds_read_b64_tr_b16 v[36:37], v154 offset:45568
    ds_read_b64_tr_b16 v[38:39], v155 offset:46720
    v_mfma_f32_32x32x16_bf16 v[116:131], v[20:23], v[48:51], v[116:131]
    ds_read_b64_tr_b16 v[40:41], v162 offset:40960
    ds_read_b64_tr_b16 v[42:43], v163 offset:40960
    v_mfma_f32_32x32x16_bf16 v[132:147], v[20:23], v[52:55], v[132:147]
    s_waitcnt lgkmcnt(8)
    v_mfma_f32_32x32x16_bf16 v[68:83], v[24:27], v[56:59], v[68:83]
    ds_read_b128 v[16:19], v150 offset:32768
    ds_read_b128 v[20:23], v150 offset:36864
    v_mfma_f32_32x32x16_bf16 v[84:99], v[24:27], v[60:63], v[84:99]
    ds_read_b64_tr_b16 v[44:45], v152 offset:50176
    ds_read_b64_tr_b16 v[46:47], v153 offset:51328
    v_mfma_f32_32x32x16_bf16 v[100:115], v[28:31], v[56:59], v[100:115]
    ds_read_b64_tr_b16 v[48:49], v154 offset:50176
    ds_read_b64_tr_b16 v[50:51], v155 offset:51328
    v_mfma_f32_32x32x16_bf16 v[116:131], v[28:31], v[60:63], v[116:131]
    ds_read_b64_tr_b16 v[52:53], v164 offset:40960
    ds_read_b64_tr_b16 v[54:55], v165 offset:40960
    v_mfma_f32_32x32x16_bf16 v[132:147], v[28:31], v[64:67], v[132:147]
    s_waitcnt lgkmcnt(8)
    v_mfma_f32_32x32x16_bf16 v[68:83], v[8:11], v[32:35], v[68:83]
    ds_read_b128 v[24:27], v151 offset:32768
    ds_read_b128 v[28:31], v151 offset:36864
    v_mfma_f32_32x32x16_bf16 v[84:99], v[8:11], v[36:39], v[84:99]
    ds_read_b64_tr_b16 v[56:57], v152 offset:54784
    ds_read_b64_tr_b16 v[58:59], v153 offset:55936
    v_mfma_f32_32x32x16_bf16 v[100:115], v[12:15], v[32:35], v[100:115]
    ds_read_b64_tr_b16 v[60:61], v154 offset:54784
    ds_read_b64_tr_b16 v[62:63], v155 offset:55936
    v_mfma_f32_32x32x16_bf16 v[116:131], v[12:15], v[36:39], v[116:131]
    ds_read_b64_tr_b16 v[64:65], v166 offset:40960
    ds_read_b64_tr_b16 v[66:67], v167 offset:40960
    v_mfma_f32_32x32x16_bf16 v[132:147], v[12:15], v[40:43], v[132:147]
    s_waitcnt lgkmcnt(0)
    s_barrier
    v_mfma_f32_32x32x16_bf16 v[68:83], v[16:19], v[44:47], v[68:83]
    ds_read_b128 v[8:11], v148 offset:49152
    ds_read_b128 v[12:15], v148 offset:53248
    v_mfma_f32_32x32x16_bf16 v[84:99], v[16:19], v[48:51], v[84:99]
    ds_read_b64_tr_b16 v[32:33], v156 offset:0
    ds_read_b64_tr_b16 v[34:35], v157 offset:1152
    v_mfma_f32_32x32x16_bf16 v[100:115], v[20:23], v[44:47], v[100:115]
    ds_read_b64_tr_b16 v[36:37], v158 offset:0
    ds_read_b64_tr_b16 v[38:39], v159 offset:1152
    v_mfma_f32_32x32x16_bf16 v[116:131], v[20:23], v[48:51], v[116:131]
    ds_read_b64_tr_b16 v[40:41], v168 offset:0
    ds_read_b64_tr_b16 v[42:43], v169 offset:0
    v_mfma_f32_32x32x16_bf16 v[132:147], v[20:23], v[52:55], v[132:147]
    v_mfma_f32_32x32x16_bf16 v[68:83], v[24:27], v[56:59], v[68:83]
    ds_read_b128 v[16:19], v149 offset:49152
    ds_read_b128 v[20:23], v149 offset:53248
    v_mfma_f32_32x32x16_bf16 v[84:99], v[24:27], v[60:63], v[84:99]
    ds_read_b64_tr_b16 v[44:45], v156 offset:4608
    ds_read_b64_tr_b16 v[46:47], v157 offset:5760
    v_mfma_f32_32x32x16_bf16 v[100:115], v[28:31], v[56:59], v[100:115]
    ds_read_b64_tr_b16 v[48:49], v158 offset:4608
    ds_read_b64_tr_b16 v[50:51], v159 offset:5760
    v_mfma_f32_32x32x16_bf16 v[116:131], v[28:31], v[60:63], v[116:131]
    ds_read_b64_tr_b16 v[52:53], v170 offset:0
    ds_read_b64_tr_b16 v[54:55], v171 offset:0
    v_mfma_f32_32x32x16_bf16 v[132:147], v[28:31], v[64:67], v[132:147]
    s_waitcnt lgkmcnt(8)
    v_mfma_f32_32x32x16_bf16 v[68:83], v[8:11], v[32:35], v[68:83]
    ds_read_b128 v[24:27], v150 offset:49152
    ds_read_b128 v[28:31], v150 offset:53248
    v_mfma_f32_32x32x16_bf16 v[84:99], v[8:11], v[36:39], v[84:99]
    ds_read_b64_tr_b16 v[56:57], v156 offset:9216
    ds_read_b64_tr_b16 v[58:59], v157 offset:10368
    v_mfma_f32_32x32x16_bf16 v[100:115], v[12:15], v[32:35], v[100:115]
    ds_read_b64_tr_b16 v[60:61], v158 offset:9216
    ds_read_b64_tr_b16 v[62:63], v159 offset:10368
    v_mfma_f32_32x32x16_bf16 v[116:131], v[12:15], v[36:39], v[116:131]
    ds_read_b64_tr_b16 v[64:65], v172 offset:0
    ds_read_b64_tr_b16 v[66:67], v173 offset:0
    v_mfma_f32_32x32x16_bf16 v[132:147], v[12:15], v[40:43], v[132:147]
    s_waitcnt lgkmcnt(8)
    v_mfma_f32_32x32x16_bf16 v[68:83], v[16:19], v[44:47], v[68:83]
    ds_read_b128 v[8:11], v151 offset:49152
    ds_read_b128 v[12:15], v151 offset:53248
    v_mfma_f32_32x32x16_bf16 v[84:99], v[16:19], v[48:51], v[84:99]
    ds_read_b64_tr_b16 v[32:33], v156 offset:13824
    ds_read_b64_tr_b16 v[34:35], v157 offset:14976
    v_mfma_f32_32x32x16_bf16 v[100:115], v[20:23], v[44:47], v[100:115]
    ds_read_b64_tr_b16 v[36:37], v158 offset:13824
    ds_read_b64_tr_b16 v[38:39], v159 offset:14976
    v_mfma_f32_32x32x16_bf16 v[116:131], v[20:23], v[48:51], v[116:131]
    ds_read_b64_tr_b16 v[40:41], v174 offset:0
    ds_read_b64_tr_b16 v[42:43], v175 offset:0
    v_mfma_f32_32x32x16_bf16 v[132:147], v[20:23], v[52:55], v[132:147]
    s_waitcnt lgkmcnt(0)
    s_barrier
    v_mfma_f32_32x32x16_bf16 v[68:83], v[24:27], v[56:59], v[68:83]
    ds_read_b128 v[16:19], v148 offset:0
    ds_read_b128 v[20:23], v148 offset:4096
    v_mfma_f32_32x32x16_bf16 v[84:99], v[24:27], v[60:63], v[84:99]
    ds_read_b64_tr_b16 v[44:45], v152 offset:0
    ds_read_b64_tr_b16 v[46:47], v153 offset:1152
    v_mfma_f32_32x32x16_bf16 v[100:115], v[28:31], v[56:59], v[100:115]
    ds_read_b64_tr_b16 v[48:49], v154 offset:0
    ds_read_b64_tr_b16 v[50:51], v155 offset:1152
    v_mfma_f32_32x32x16_bf16 v[116:131], v[28:31], v[60:63], v[116:131]
    ds_read_b64_tr_b16 v[52:53], v160 offset:0
    ds_read_b64_tr_b16 v[54:55], v161 offset:0
    v_mfma_f32_32x32x16_bf16 v[132:147], v[28:31], v[64:67], v[132:147]
    v_mfma_f32_32x32x16_bf16 v[68:83], v[8:11], v[32:35], v[68:83]
    ds_read_b128 v[24:27], v149 offset:0
    ds_read_b128 v[28:31], v149 offset:4096
    v_mfma_f32_32x32x16_bf16 v[84:99], v[8:11], v[36:39], v[84:99]
    ds_read_b64_tr_b16 v[56:57], v152 offset:4608
    ds_read_b64_tr_b16 v[58:59], v153 offset:5760
    v_mfma_f32_32x32x16_bf16 v[100:115], v[12:15], v[32:35], v[100:115]
    ds_read_b64_tr_b16 v[60:61], v154 offset:4608
    ds_read_b64_tr_b16 v[62:63], v155 offset:5760
    v_mfma_f32_32x32x16_bf16 v[116:131], v[12:15], v[36:39], v[116:131]
    ds_read_b64_tr_b16 v[64:65], v162 offset:0
    ds_read_b64_tr_b16 v[66:67], v163 offset:0
    v_mfma_f32_32x32x16_bf16 v[132:147], v[12:15], v[40:43], v[132:147]
    s_waitcnt lgkmcnt(8)
    v_mfma_f32_32x32x16_bf16 v[68:83], v[16:19], v[44:47], v[68:83]
    ds_read_b128 v[8:11], v150 offset:0
    ds_read_b128 v[12:15], v150 offset:4096
    v_mfma_f32_32x32x16_bf16 v[84:99], v[16:19], v[48:51], v[84:99]
    ds_read_b64_tr_b16 v[32:33], v152 offset:9216
    ds_read_b64_tr_b16 v[34:35], v153 offset:10368
    v_mfma_f32_32x32x16_bf16 v[100:115], v[20:23], v[44:47], v[100:115]
    ds_read_b64_tr_b16 v[36:37], v154 offset:9216
    ds_read_b64_tr_b16 v[38:39], v155 offset:10368
    v_mfma_f32_32x32x16_bf16 v[116:131], v[20:23], v[48:51], v[116:131]
    ds_read_b64_tr_b16 v[40:41], v164 offset:0
    ds_read_b64_tr_b16 v[42:43], v165 offset:0
    v_mfma_f32_32x32x16_bf16 v[132:147], v[20:23], v[52:55], v[132:147]
    s_waitcnt lgkmcnt(8)
    v_mfma_f32_32x32x16_bf16 v[68:83], v[24:27], v[56:59], v[68:83]
    ds_read_b128 v[16:19], v151 offset:0
    ds_read_b128 v[20:23], v151 offset:4096
    v_mfma_f32_32x32x16_bf16 v[84:99], v[24:27], v[60:63], v[84:99]
    ds_read_b64_tr_b16 v[44:45], v152 offset:13824
    ds_read_b64_tr_b16 v[46:47], v153 offset:14976
    v_mfma_f32_32x32x16_bf16 v[100:115], v[28:31], v[56:59], v[100:115]
    ds_read_b64_tr_b16 v[48:49], v154 offset:13824
    ds_read_b64_tr_b16 v[50:51], v155 offset:14976
    v_mfma_f32_32x32x16_bf16 v[116:131], v[28:31], v[60:63], v[116:131]
    ds_read_b64_tr_b16 v[52:53], v166 offset:0
    ds_read_b64_tr_b16 v[54:55], v167 offset:0
    v_mfma_f32_32x32x16_bf16 v[132:147], v[28:31], v[64:67], v[132:147]
    s_waitcnt lgkmcnt(0)
    s_barrier
    v_mfma_f32_32x32x16_bf16 v[68:83], v[8:11], v[32:35], v[68:83]
    ds_read_b128 v[24:27], v148 offset:16384
    ds_read_b128 v[28:31], v148 offset:20480
    v_mfma_f32_32x32x16_bf16 v[84:99], v[8:11], v[36:39], v[84:99]
    ds_read_b64_tr_b16 v[56:57], v152 offset:20480
    ds_read_b64_tr_b16 v[58:59], v153 offset:21632
    v_mfma_f32_32x32x16_bf16 v[100:115], v[12:15], v[32:35], v[100:115]
    ds_read_b64_tr_b16 v[60:61], v154 offset:20480
    ds_read_b64_tr_b16 v[62:63], v155 offset:21632
    v_mfma_f32_32x32x16_bf16 v[116:131], v[12:15], v[36:39], v[116:131]
    ds_read_b64_tr_b16 v[64:65], v160 offset:20480
    ds_read_b64_tr_b16 v[66:67], v161 offset:20480
    v_mfma_f32_32x32x16_bf16 v[132:147], v[12:15], v[40:43], v[132:147]
    v_mfma_f32_32x32x16_bf16 v[68:83], v[16:19], v[44:47], v[68:83]
    ds_read_b128 v[8:11], v149 offset:16384
    ds_read_b128 v[12:15], v149 offset:20480
    v_mfma_f32_32x32x16_bf16 v[84:99], v[16:19], v[48:51], v[84:99]
    ds_read_b64_tr_b16 v[32:33], v152 offset:25088
    ds_read_b64_tr_b16 v[34:35], v153 offset:26240
    v_mfma_f32_32x32x16_bf16 v[100:115], v[20:23], v[44:47], v[100:115]
    ds_read_b64_tr_b16 v[36:37], v154 offset:25088
    ds_read_b64_tr_b16 v[38:39], v155 offset:26240
    v_mfma_f32_32x32x16_bf16 v[116:131], v[20:23], v[48:51], v[116:131]
    ds_read_b64_tr_b16 v[40:41], v162 offset:20480
    ds_read_b64_tr_b16 v[42:43], v163 offset:20480
    v_mfma_f32_32x32x16_bf16 v[132:147], v[20:23], v[52:55], v[132:147]
    s_waitcnt lgkmcnt(8)
    v_mfma_f32_32x32x16_bf16 v[68:83], v[24:27], v[56:59], v[68:83]
    ds_read_b128 v[16:19], v150 offset:16384
    ds_read_b128 v[20:23], v150 offset:20480
    v_mfma_f32_32x32x16_bf16 v[84:99], v[24:27], v[60:63], v[84:99]
    ds_read_b64_tr_b16 v[44:45], v152 offset:29696
    ds_read_b64_tr_b16 v[46:47], v153 offset:30848
    v_mfma_f32_32x32x16_bf16 v[100:115], v[28:31], v[56:59], v[100:115]
    ds_read_b64_tr_b16 v[48:49], v154 offset:29696
    ds_read_b64_tr_b16 v[50:51], v155 offset:30848
    v_mfma_f32_32x32x16_bf16 v[116:131], v[28:31], v[60:63], v[116:131]
    ds_read_b64_tr_b16 v[52:53], v164 offset:20480
    ds_read_b64_tr_b16 v[54:55], v165 offset:20480
    v_mfma_f32_32x32x16_bf16 v[132:147], v[28:31], v[64:67], v[132:147]
    s_waitcnt lgkmcnt(8)
    v_mfma_f32_32x32x16_bf16 v[68:83], v[8:11], v[32:35], v[68:83]
    ds_read_b128 v[24:27], v151 offset:16384
    ds_read_b128 v[28:31], v151 offset:20480
    v_mfma_f32_32x32x16_bf16 v[84:99], v[8:11], v[36:39], v[84:99]
    ds_read_b64_tr_b16 v[56:57], v152 offset:34304
    ds_read_b64_tr_b16 v[58:59], v153 offset:35456
    v_mfma_f32_32x32x16_bf16 v[100:115], v[12:15], v[32:35], v[100:115]
    ds_read_b64_tr_b16 v[60:61], v154 offset:34304
    ds_read_b64_tr_b16 v[62:63], v155 offset:35456
    v_mfma_f32_32x32x16_bf16 v[116:131], v[12:15], v[36:39], v[116:131]
    ds_read_b64_tr_b16 v[64:65], v166 offset:20480
    ds_read_b64_tr_b16 v[66:67], v167 offset:20480
    v_mfma_f32_32x32x16_bf16 v[132:147], v[12:15], v[40:43], v[132:147]
    s_waitcnt lgkmcnt(0)
    s_barrier
    v_mfma_f32_32x32x16_bf16 v[68:83], v[16:19], v[44:47], v[68:83]
    ds_read_b128 v[8:11], v148 offset:32768
    ds_read_b128 v[12:15], v148 offset:36864
    v_mfma_f32_32x32x16_bf16 v[84:99], v[16:19], v[48:51], v[84:99]
    ds_read_b64_tr_b16 v[32:33], v152 offset:40960
    ds_read_b64_tr_b16 v[34:35], v153 offset:42112
    v_mfma_f32_32x32x16_bf16 v[100:115], v[20:23], v[44:47], v[100:115]
    ds_read_b64_tr_b16 v[36:37], v154 offset:40960
    ds_read_b64_tr_b16 v[38:39], v155 offset:42112
    v_mfma_f32_32x32x16_bf16 v[116:131], v[20:23], v[48:51], v[116:131]
    ds_read_b64_tr_b16 v[40:41], v160 offset:40960
    ds_read_b64_tr_b16 v[42:43], v161 offset:40960
    v_mfma_f32_32x32x16_bf16 v[132:147], v[20:23], v[52:55], v[132:147]
    v_mfma_f32_32x32x16_bf16 v[68:83], v[24:27], v[56:59], v[68:83]
    ds_read_b128 v[16:19], v149 offset:32768
    ds_read_b128 v[20:23], v149 offset:36864
    v_mfma_f32_32x32x16_bf16 v[84:99], v[24:27], v[60:63], v[84:99]
    ds_read_b64_tr_b16 v[44:45], v152 offset:45568
    ds_read_b64_tr_b16 v[46:47], v153 offset:46720
    v_mfma_f32_32x32x16_bf16 v[100:115], v[28:31], v[56:59], v[100:115]
    ds_read_b64_tr_b16 v[48:49], v154 offset:45568
    ds_read_b64_tr_b16 v[50:51], v155 offset:46720
    v_mfma_f32_32x32x16_bf16 v[116:131], v[28:31], v[60:63], v[116:131]
    ds_read_b64_tr_b16 v[52:53], v162 offset:40960
    ds_read_b64_tr_b16 v[54:55], v163 offset:40960
    v_mfma_f32_32x32x16_bf16 v[132:147], v[28:31], v[64:67], v[132:147]
    s_waitcnt lgkmcnt(8)
    buffer_load_dword v194, v195, s[28:31], 0 offen sc1
    v_mfma_f32_32x32x16_bf16 v[68:83], v[8:11], v[32:35], v[68:83]
    ds_read_b128 v[24:27], v150 offset:32768
    ds_read_b128 v[28:31], v150 offset:36864
    v_mfma_f32_32x32x16_bf16 v[84:99], v[8:11], v[36:39], v[84:99]
    ds_read_b64_tr_b16 v[56:57], v152 offset:50176
    ds_read_b64_tr_b16 v[58:59], v153 offset:51328
    v_mfma_f32_32x32x16_bf16 v[100:115], v[12:15], v[32:35], v[100:115]
    ds_read_b64_tr_b16 v[60:61], v154 offset:50176
    ds_read_b64_tr_b16 v[62:63], v155 offset:51328
    v_mfma_f32_32x32x16_bf16 v[116:131], v[12:15], v[36:39], v[116:131]
    ds_read_b64_tr_b16 v[64:65], v164 offset:40960
    ds_read_b64_tr_b16 v[66:67], v165 offset:40960
    v_mfma_f32_32x32x16_bf16 v[132:147], v[12:15], v[40:43], v[132:147]
    s_waitcnt lgkmcnt(8)
    v_mfma_f32_32x32x16_bf16 v[68:83], v[16:19], v[44:47], v[68:83]
    ds_read_b128 v[8:11], v151 offset:32768
    ds_read_b128 v[12:15], v151 offset:36864
    v_mfma_f32_32x32x16_bf16 v[84:99], v[16:19], v[48:51], v[84:99]
    ds_read_b64_tr_b16 v[32:33], v152 offset:54784
    ds_read_b64_tr_b16 v[34:35], v153 offset:55936
    v_mfma_f32_32x32x16_bf16 v[100:115], v[20:23], v[44:47], v[100:115]
    ds_read_b64_tr_b16 v[36:37], v154 offset:54784
    ds_read_b64_tr_b16 v[38:39], v155 offset:55936
    v_mfma_f32_32x32x16_bf16 v[116:131], v[20:23], v[48:51], v[116:131]
    ds_read_b64_tr_b16 v[40:41], v166 offset:40960
    ds_read_b64_tr_b16 v[42:43], v167 offset:40960
    v_mfma_f32_32x32x16_bf16 v[132:147], v[20:23], v[52:55], v[132:147]
    s_waitcnt lgkmcnt(0)
    s_barrier
    v_mfma_f32_32x32x16_bf16 v[68:83], v[24:27], v[56:59], v[68:83]
    ds_read_b128 v[16:19], v148 offset:49152
    ds_read_b128 v[20:23], v148 offset:53248
    v_mfma_f32_32x32x16_bf16 v[84:99], v[24:27], v[60:63], v[84:99]
    ds_read_b64_tr_b16 v[44:45], v156 offset:0
    ds_read_b64_tr_b16 v[46:47], v157 offset:1152
    v_mfma_f32_32x32x16_bf16 v[100:115], v[28:31], v[56:59], v[100:115]
    ds_read_b64_tr_b16 v[48:49], v158 offset:0
    ds_read_b64_tr_b16 v[50:51], v159 offset:1152
    v_mfma_f32_32x32x16_bf16 v[116:131], v[28:31], v[60:63], v[116:131]
    ds_read_b64_tr_b16 v[52:53], v168 offset:0
    ds_read_b64_tr_b16 v[54:55], v169 offset:0
    v_mfma_f32_32x32x16_bf16 v[132:147], v[28:31], v[64:67], v[132:147]
    v_mfma_f32_32x32x16_bf16 v[68:83], v[8:11], v[32:35], v[68:83]
    ds_read_b128 v[24:27], v149 offset:49152
    ds_read_b128 v[28:31], v149 offset:53248
    v_mfma_f32_32x32x16_bf16 v[84:99], v[8:11], v[36:39], v[84:99]
    ds_read_b64_tr_b16 v[56:57], v156 offset:4608
    ds_read_b64_tr_b16 v[58:59], v157 offset:5760
    v_mfma_f32_32x32x16_bf16 v[100:115], v[12:15], v[32:35], v[100:115]
    ds_read_b64_tr_b16 v[60:61], v158 offset:4608
    ds_read_b64_tr_b16 v[62:63], v159 offset:5760
    v_mfma_f32_32x32x16_bf16 v[116:131], v[12:15], v[36:39], v[116:131]
    ds_read_b64_tr_b16 v[64:65], v170 offset:0
    ds_read_b64_tr_b16 v[66:67], v171 offset:0
    v_mfma_f32_32x32x16_bf16 v[132:147], v[12:15], v[40:43], v[132:147]
    s_waitcnt lgkmcnt(8)
    v_mfma_f32_32x32x16_bf16 v[68:83], v[16:19], v[44:47], v[68:83]
    ds_read_b128 v[8:11], v150 offset:49152
    ds_read_b128 v[12:15], v150 offset:53248
    v_mfma_f32_32x32x16_bf16 v[84:99], v[16:19], v[48:51], v[84:99]
    ds_read_b64_tr_b16 v[32:33], v156 offset:9216
    ds_read_b64_tr_b16 v[34:35], v157 offset:10368
    v_mfma_f32_32x32x16_bf16 v[100:115], v[20:23], v[44:47], v[100:115]
    ds_read_b64_tr_b16 v[36:37], v158 offset:9216
    ds_read_b64_tr_b16 v[38:39], v159 offset:10368
    v_mfma_f32_32x32x16_bf16 v[116:131], v[20:23], v[48:51], v[116:131]
    ds_read_b64_tr_b16 v[40:41], v172 offset:0
    ds_read_b64_tr_b16 v[42:43], v173 offset:0
    v_mfma_f32_32x32x16_bf16 v[132:147], v[20:23], v[52:55], v[132:147]
    s_waitcnt lgkmcnt(8)
    v_mfma_f32_32x32x16_bf16 v[68:83], v[24:27], v[56:59], v[68:83]
    ds_read_b128 v[16:19], v151 offset:49152
    ds_read_b128 v[20:23], v151 offset:53248
    v_mfma_f32_32x32x16_bf16 v[84:99], v[24:27], v[60:63], v[84:99]
    ds_read_b64_tr_b16 v[44:45], v156 offset:13824
    ds_read_b64_tr_b16 v[46:47], v157 offset:14976
    v_mfma_f32_32x32x16_bf16 v[100:115], v[28:31], v[56:59], v[100:115]
    ds_read_b64_tr_b16 v[48:49], v158 offset:13824
    ds_read_b64_tr_b16 v[50:51], v159 offset:14976
    v_mfma_f32_32x32x16_bf16 v[116:131], v[28:31], v[60:63], v[116:131]
    ds_read_b64_tr_b16 v[52:53], v174 offset:0
    ds_read_b64_tr_b16 v[54:55], v175 offset:0
    v_mfma_f32_32x32x16_bf16 v[132:147], v[28:31], v[64:67], v[132:147]
    s_waitcnt lgkmcnt(0)
    s_barrier
    v_mfma_f32_32x32x16_bf16 v[68:83], v[8:11], v[32:35], v[68:83]
    ds_read_b128 v[24:27], v148 offset:0
    ds_read_b128 v[28:31], v148 offset:4096
    v_mfma_f32_32x32x16_bf16 v[84:99], v[8:11], v[36:39], v[84:99]
    ds_read_b64_tr_b16 v[56:57], v152 offset:0
    ds_read_b64_tr_b16 v[58:59], v153 offset:1152
    v_mfma_f32_32x32x16_bf16 v[100:115], v[12:15], v[32:35], v[100:115]
    ds_read_b64_tr_b16 v[60:61], v154 offset:0
    ds_read_b64_tr_b16 v[62:63], v155 offset:1152
    v_mfma_f32_32x32x16_bf16 v[116:131], v[12:15], v[36:39], v[116:131]
    ds_read_b64_tr_b16 v[64:65], v160 offset:0
    ds_read_b64_tr_b16 v[66:67], v161 offset:0
    v_mfma_f32_32x32x16_bf16 v[132:147], v[12:15], v[40:43], v[132:147]
    v_mfma_f32_32x32x16_bf16 v[68:83], v[16:19], v[44:47], v[68:83]
    ds_read_b128 v[8:11], v149 offset:0
    ds_read_b128 v[12:15], v149 offset:4096
    v_mfma_f32_32x32x16_bf16 v[84:99], v[16:19], v[48:51], v[84:99]
    ds_read_b64_tr_b16 v[32:33], v152 offset:4608
    ds_read_b64_tr_b16 v[34:35], v153 offset:5760
    v_mfma_f32_32x32x16_bf16 v[100:115], v[20:23], v[44:47], v[100:115]
    ds_read_b64_tr_b16 v[36:37], v154 offset:4608
    ds_read_b64_tr_b16 v[38:39], v155 offset:5760
    v_mfma_f32_32x32x16_bf16 v[116:131], v[20:23], v[48:51], v[116:131]
    ds_read_b64_tr_b16 v[40:41], v162 offset:0
    ds_read_b64_tr_b16 v[42:43], v163 offset:0
    v_mfma_f32_32x32x16_bf16 v[132:147], v[20:23], v[52:55], v[132:147]
    s_waitcnt lgkmcnt(8)
    v_mfma_f32_32x32x16_bf16 v[68:83], v[24:27], v[56:59], v[68:83]
    ds_read_b128 v[16:19], v150 offset:0
    ds_read_b128 v[20:23], v150 offset:4096
    v_mfma_f32_32x32x16_bf16 v[84:99], v[24:27], v[60:63], v[84:99]
    ds_read_b64_tr_b16 v[44:45], v152 offset:9216
    ds_read_b64_tr_b16 v[46:47], v153 offset:10368
    v_mfma_f32_32x32x16_bf16 v[100:115], v[28:31], v[56:59], v[100:115]
    ds_read_b64_tr_b16 v[48:49], v154 offset:9216
    ds_read_b64_tr_b16 v[50:51], v155 offset:10368
    v_mfma_f32_32x32x16_bf16 v[116:131], v[28:31], v[60:63], v[116:131]
    ds_read_b64_tr_b16 v[52:53], v164 offset:0
    ds_read_b64_tr_b16 v[54:55], v165 offset:0
    v_mfma_f32_32x32x16_bf16 v[132:147], v[28:31], v[64:67], v[132:147]
    s_waitcnt lgkmcnt(8)
    v_mfma_f32_32x32x16_bf16 v[68:83], v[8:11], v[32:35], v[68:83]
    ds_read_b128 v[24:27], v151 offset:0
    ds_read_b128 v[28:31], v151 offset:4096
    v_mfma_f32_32x32x16_bf16 v[84:99], v[8:11], v[36:39], v[84:99]
    ds_read_b64_tr_b16 v[56:57], v152 offset:13824
    ds_read_b64_tr_b16 v[58:59], v153 offset:14976
    v_mfma_f32_32x32x16_bf16 v[100:115], v[12:15], v[32:35], v[100:115]
    ds_read_b64_tr_b16 v[60:61], v154 offset:13824
    ds_read_b64_tr_b16 v[62:63], v155 offset:14976
    v_mfma_f32_32x32x16_bf16 v[116:131], v[12:15], v[36:39], v[116:131]
    ds_read_b64_tr_b16 v[64:65], v166 offset:0
    ds_read_b64_tr_b16 v[66:67], v167 offset:0
    v_mfma_f32_32x32x16_bf16 v[132:147], v[12:15], v[40:43], v[132:147]
    s_waitcnt lgkmcnt(0)
    s_barrier
    v_mfma_f32_32x32x16_bf16 v[68:83], v[16:19], v[44:47], v[68:83]
    v_mfma_f32_32x32x16_bf16 v[84:99], v[16:19], v[48:51], v[84:99]
    v_mfma_f32_32x32x16_bf16 v[100:115], v[20:23], v[44:47], v[100:115]
    v_mfma_f32_32x32x16_bf16 v[116:131], v[20:23], v[48:51], v[116:131]
    v_mfma_f32_32x32x16_bf16 v[132:147], v[20:23], v[52:55], v[132:147]
    v_mfma_f32_32x32x16_bf16 v[68:83], v[24:27], v[56:59], v[68:83]
    v_mfma_f32_32x32x16_bf16 v[84:99], v[24:27], v[60:63], v[84:99]
    v_mfma_f32_32x32x16_bf16 v[100:115], v[28:31], v[56:59], v[100:115]
    v_mfma_f32_32x32x16_bf16 v[116:131], v[28:31], v[60:63], v[116:131]
    v_mfma_f32_32x32x16_bf16 v[132:147], v[28:31], v[64:67], v[132:147]
proj_a_kvepi:
    s_nop 7
    s_nop 7
    s_waitcnt vmcnt(0)
    v_readfirstlane_b32 s99, v194
    s_nop 3
    s_cmp_ge_u32 s99, 4
    s_cbranch_scc1 proj_vm5
    s_load_dwordx2 s[42:43], s[0:1], 80
    s_waitcnt lgkmcnt(0)
    s_mov_b32 s28, s42
    s_and_b32 s29, s43, 0xffff
    s_mov_b32 s30, 256
    s_mov_b32 s31, 0x20000
    v_mov_b32 v191, 0
    s_mov_b32 s98, 0
proj_mk6:
    buffer_load_dword v190, v191, s[28:31], 0 offen sc1
    s_waitcnt vmcnt(0)
    v_readfirstlane_b32 s99, v190
    s_nop 3
    s_cmp_ge_u32 s99, 4
    s_cbranch_scc1 proj_mk6_ok
    s_add_u32 s98, s98, 1
    s_cmp_lt_u32 s98, 0x40000
    s_cbranch_scc0 proj_mk6_ok
    s_sleep 2
    s_branch proj_mk6
proj_mk6_ok:
proj_vm5:
    s_and_b32 s42, s14, 1
    s_lshl_b32 s43, s42, 1
    s_add_u32 s45, s43, s47
    s_lshl_b32 s46, s12, 2
    s_add_u32 s46, s46, s45
    s_and_b32 s42, s13, 14
    s_cmp_eq_u32 s42, 8
    s_cbranch_scc0 proj_noV
    v_cvt_pk_bf16_f32 v8, v132, v133
    v_cvt_pk_bf16_f32 v9, v134, v135
    v_cvt_pk_bf16_f32 v10, v136, v137
    v_cvt_pk_bf16_f32 v11, v138, v139
    v_cvt_pk_bf16_f32 v12, v140, v141
    v_cvt_pk_bf16_f32 v13, v142, v143
    v_cvt_pk_bf16_f32 v14, v144, v145
    v_cvt_pk_bf16_f32 v15, v146, v147
    s_and_b32 s43, s13, 1
    v_subrev_u32 v178, 16, v1
    s_cmp_eq_u32 s43, 0
    s_cselect_b32 s44, 16, 4
    s_nop 0
    s_mov_b32 s98, 64
    s_cmov_b32 s98, 256
    s_mov_b32 s99, 2176
    s_cmov_b32 s99, 1152
    v_cmp_gt_u32 vcc, s44, v178
    v_lshlrev_b32 v179, 4, v178
    v_mul_lo_u32 v180, v2, s98
    v_add_u32 v179, v179, v180
    v_add_u32 v179, s99, v179
    v_mov_b32 v180, 2146435072
    v_cndmask_b32 v179, v180, v179, vcc
    v_cmp_eq_u32 vcc, 18, v1
    s_cmp_eq_u32 s43, 1
    s_cselect_b64 s[42:43], -1, 0
    s_nop 1
    s_and_b64 vcc, vcc, s[42:43]
    v_mov_b32 v181, 0x3f803f80
    v_cndmask_b32 v8, v8, v181, vcc
    v_cndmask_b32 v9, v9, v181, vcc
    v_cndmask_b32 v10, v10, v181, vcc
    v_cndmask_b32 v11, v11, v181, vcc
    v_cndmask_b32 v12, v12, v181, vcc
    v_cndmask_b32 v13, v13, v181, vcc
    v_cndmask_b32 v14, v14, v181, vcc
    v_cndmask_b32 v15, v15, v181, vcc
    s_mul_i32 s42, s46, 2432
    s_add_u32 s42, s42, 4718592
    buffer_store_dwordx4 v[8:11], v179, s[32:35], s42 offen sc1
    s_cmp_eq_u32 s43, 0
    s_mov_b32 s98, 128
    s_cmov_b32 s98, 512
    s_add_u32 s42, s42, s98
    buffer_store_dwordx4 v[12:15], v179, s[32:35], s42 offen sc1
proj_noV:
    v_mov_b32 v186, 1069066811
    v_mov_b32 v187, 1069066811
    v_mov_b32 v188, 897988541
    v_mov_b32 v189, 897988541
    v_pk_mul_f32 v[16:17], v[68:69], v[186:187]
    v_pk_mul_f32 v[18:19], v[70:71], v[186:187]
    v_pk_mul_f32 v[20:21], v[72:73], v[186:187]
    v_pk_mul_f32 v[22:23], v[74:75], v[186:187]
    v_pk_mul_f32 v[24:25], v[76:77], v[186:187]
    v_pk_mul_f32 v[26:27], v[78:79], v[186:187]
    v_pk_mul_f32 v[28:29], v[80:81], v[186:187]
    v_pk_mul_f32 v[30:31], v[82:83], v[186:187]
    v_exp_f32 v16, v16 clamp
    v_exp_f32 v17, v17 clamp
    v_exp_f32 v18, v18 clamp
    v_exp_f32 v19, v19 clamp
    v_exp_f32 v20, v20 clamp
    v_exp_f32 v21, v21 clamp
    v_exp_f32 v22, v22 clamp
    v_exp_f32 v23, v23 clamp
    v_exp_f32 v24, v24 clamp
    v_exp_f32 v25, v25 clamp
    v_exp_f32 v26, v26 clamp
    v_exp_f32 v27, v27 clamp
    v_exp_f32 v28, v28 clamp
    v_exp_f32 v29, v29 clamp
    v_exp_f32 v30, v30 clamp
    v_exp_f32 v31, v31 clamp
    v_max_f32 v68, 0, v68
    v_max_f32 v69, 0, v69
    v_max_f32 v70, 0, v70
    v_max_f32 v71, 0, v71
    v_max_f32 v72, 0, v72
    v_max_f32 v73, 0, v73
    v_max_f32 v74, 0, v74
    v_max_f32 v75, 0, v75
    v_max_f32 v76, 0, v76
    v_max_f32 v77, 0, v77
    v_max_f32 v78, 0, v78
    v_max_f32 v79, 0, v79
    v_max_f32 v80, 0, v80
    v_max_f32 v81, 0, v81
    v_max_f32 v82, 0, v82
    v_max_f32 v83, 0, v83
    v_pk_add_f32 v[16:17], v[16:17], v[188:189]
    v_pk_add_f32 v[18:19], v[18:19], v[188:189]
    v_pk_add_f32 v[20:21], v[20:21], v[188:189]
    v_pk_add_f32 v[22:23], v[22:23], v[188:189]
    v_pk_add_f32 v[24:25], v[24:25], v[188:189]
    v_pk_add_f32 v[26:27], v[26:27], v[188:189]
    v_pk_add_f32 v[28:29], v[28:29], v[188:189]
    v_pk_add_f32 v[30:31], v[30:31], v[188:189]
    v_pk_add_f32 v[68:69], v[68:69], v[16:17]
    v_pk_add_f32 v[70:71], v[70:71], v[18:19]
    v_pk_add_f32 v[72:73], v[72:73], v[20:21]
    v_pk_add_f32 v[74:75], v[74:75], v[22:23]
    v_pk_add_f32 v[76:77], v[76:77], v[24:25]
    v_pk_add_f32 v[78:79], v[78:79], v[26:27]
    v_pk_add_f32 v[80:81], v[80:81], v[28:29]
    v_pk_add_f32 v[82:83], v[82:83], v[30:31]
    v_mov_b32 v186, 1069066811
    v_mov_b32 v187, 1069066811
    v_mov_b32 v188, 897988541
    v_mov_b32 v189, 897988541
    v_pk_mul_f32 v[16:17], v[100:101], v[186:187]
    v_pk_mul_f32 v[18:19], v[102:103], v[186:187]
    v_pk_mul_f32 v[20:21], v[104:105], v[186:187]
    v_pk_mul_f32 v[22:23], v[106:107], v[186:187]
    v_pk_mul_f32 v[24:25], v[108:109], v[186:187]
    v_pk_mul_f32 v[26:27], v[110:111], v[186:187]
    v_pk_mul_f32 v[28:29], v[112:113], v[186:187]
    v_pk_mul_f32 v[30:31], v[114:115], v[186:187]
    v_exp_f32 v16, v16 clamp
    v_exp_f32 v17, v17 clamp
    v_exp_f32 v18, v18 clamp
    v_exp_f32 v19, v19 clamp
    v_exp_f32 v20, v20 clamp
    v_exp_f32 v21, v21 clamp
    v_exp_f32 v22, v22 clamp
    v_exp_f32 v23, v23 clamp
    v_exp_f32 v24, v24 clamp
    v_exp_f32 v25, v25 clamp
    v_exp_f32 v26, v26 clamp
    v_exp_f32 v27, v27 clamp
    v_exp_f32 v28, v28 clamp
    v_exp_f32 v29, v29 clamp
    v_exp_f32 v30, v30 clamp
    v_exp_f32 v31, v31 clamp
    v_max_f32 v100, 0, v100
    v_max_f32 v101, 0, v101
    v_max_f32 v102, 0, v102
    v_max_f32 v103, 0, v103
    v_max_f32 v104, 0, v104
    v_max_f32 v105, 0, v105
    v_max_f32 v106, 0, v106
    v_max_f32 v107, 0, v107
    v_max_f32 v108, 0, v108
    v_max_f32 v109, 0, v109
    v_max_f32 v110, 0, v110
    v_max_f32 v111, 0, v111
    v_max_f32 v112, 0, v112
    v_max_f32 v113, 0, v113
    v_max_f32 v114, 0, v114
    v_max_f32 v115, 0, v115
    v_pk_add_f32 v[16:17], v[16:17], v[188:189]
    v_pk_add_f32 v[18:19], v[18:19], v[188:189]
    v_pk_add_f32 v[20:21], v[20:21], v[188:189]
    v_pk_add_f32 v[22:23], v[22:23], v[188:189]
    v_pk_add_f32 v[24:25], v[24:25], v[188:189]
    v_pk_add_f32 v[26:27], v[26:27], v[188:189]
    v_pk_add_f32 v[28:29], v[28:29], v[188:189]
    v_pk_add_f32 v[30:31], v[30:31], v[188:189]
    v_pk_add_f32 v[100:101], v[100:101], v[16:17]
    v_pk_add_f32 v[102:103], v[102:103], v[18:19]
    v_pk_add_f32 v[104:105], v[104:105], v[20:21]
    v_pk_add_f32 v[106:107], v[106:107], v[22:23]
    v_pk_add_f32 v[108:109], v[108:109], v[24:25]
    v_pk_add_f32 v[110:111], v[110:111], v[26:27]
    v_pk_add_f32 v[112:113], v[112:113], v[28:29]
    v_pk_add_f32 v[114:115], v[114:115], v[30:31]
    s_and_b32 s42, s13, 14
    s_cmp_eq_u32 s42, 8
    s_cbranch_scc0 proj_noVs
    s_waitcnt vmcnt(0)
    v_mov_b32 v190, 163832
    v_mov_b32 v191, 1
    s_mov_b32 exec_hi, 0
    s_mov_b32 exec_lo, 1
    ds_add_u32 v190, v191
    s_mov_b64 exec, -1
proj_noVs:
    v_mov_b32 v32, v132
    v_mov_b32 v33, v133
    v_mov_b32 v34, v134
    v_mov_b32 v35, v135
    v_mov_b32 v36, v136
    v_mov_b32 v37, v137
    v_mov_b32 v38, v138
    v_mov_b32 v39, v139
    v_mov_b32 v40, v140
    v_mov_b32 v41, v141
    v_mov_b32 v42, v142
    v_mov_b32 v43, v143
    v_mov_b32 v44, v144
    v_mov_b32 v45, v145
    v_mov_b32 v46, v146
    v_mov_b32 v47, v147
    v_mov_b32 v186, 1069066811
    v_mov_b32 v187, 1069066811
    v_mov_b32 v188, 897988541
    v_mov_b32 v189, 897988541
    v_pk_mul_f32 v[16:17], v[32:33], v[186:187]
    v_pk_mul_f32 v[18:19], v[34:35], v[186:187]
    v_pk_mul_f32 v[20:21], v[36:37], v[186:187]
    v_pk_mul_f32 v[22:23], v[38:39], v[186:187]
    v_pk_mul_f32 v[24:25], v[40:41], v[186:187]
    v_pk_mul_f32 v[26:27], v[42:43], v[186:187]
    v_pk_mul_f32 v[28:29], v[44:45], v[186:187]
    v_pk_mul_f32 v[30:31], v[46:47], v[186:187]
    v_exp_f32 v16, v16 clamp
    v_exp_f32 v17, v17 clamp
    v_exp_f32 v18, v18 clamp
    v_exp_f32 v19, v19 clamp
    v_exp_f32 v20, v20 clamp
    v_exp_f32 v21, v21 clamp
    v_exp_f32 v22, v22 clamp
    v_exp_f32 v23, v23 clamp
    v_exp_f32 v24, v24 clamp
    v_exp_f32 v25, v25 clamp
    v_exp_f32 v26, v26 clamp
    v_exp_f32 v27, v27 clamp
    v_exp_f32 v28, v28 clamp
    v_exp_f32 v29, v29 clamp
    v_exp_f32 v30, v30 clamp
    v_exp_f32 v31, v31 clamp
    v_max_f32 v32, 0, v32
    v_max_f32 v33, 0, v33
    v_max_f32 v34, 0, v34
    v_max_f32 v35, 0, v35
    v_max_f32 v36, 0, v36
    v_max_f32 v37, 0, v37
    v_max_f32 v38, 0, v38
    v_max_f32 v39, 0, v39
    v_max_f32 v40, 0, v40
    v_max_f32 v41, 0, v41
    v_max_f32 v42, 0, v42
    v_max_f32 v43, 0, v43
    v_max_f32 v44, 0, v44
    v_max_f32 v45, 0, v45
    v_max_f32 v46, 0, v46
    v_max_f32 v47, 0, v47
    v_pk_add_f32 v[16:17], v[16:17], v[188:189]
    v_pk_add_f32 v[18:19], v[18:19], v[188:189]
    v_pk_add_f32 v[20:21], v[20:21], v[188:189]
    v_pk_add_f32 v[22:23], v[22:23], v[188:189]
    v_pk_add_f32 v[24:25], v[24:25], v[188:189]
    v_pk_add_f32 v[26:27], v[26:27], v[188:189]
    v_pk_add_f32 v[28:29], v[28:29], v[188:189]
    v_pk_add_f32 v[30:31], v[30:31], v[188:189]
    v_pk_add_f32 v[32:33], v[32:33], v[16:17]
    v_pk_add_f32 v[34:35], v[34:35], v[18:19]
    v_pk_add_f32 v[36:37], v[36:37], v[20:21]
    v_pk_add_f32 v[38:39], v[38:39], v[22:23]
    v_pk_add_f32 v[40:41], v[40:41], v[24:25]
    v_pk_add_f32 v[42:43], v[42:43], v[26:27]
    v_pk_add_f32 v[44:45], v[44:45], v[28:29]
    v_pk_add_f32 v[46:47], v[46:47], v[30:31]
    v_cmp_gt_u32 vcc, 8, v1
    s_nop 1
    v_cndmask_b32 v132, v132, v32, vcc
    v_cndmask_b32 v133, v133, v33, vcc
    v_cndmask_b32 v134, v134, v34, vcc
    v_cndmask_b32 v135, v135, v35, vcc
    v_cndmask_b32 v136, v136, v36, vcc
    v_cndmask_b32 v137, v137, v37, vcc
    v_cndmask_b32 v138, v138, v38, vcc
    v_cndmask_b32 v139, v139, v39, vcc
    v_cndmask_b32 v140, v140, v40, vcc
    v_cndmask_b32 v141, v141, v41, vcc
    v_cndmask_b32 v142, v142, v42, vcc
    v_cndmask_b32 v143, v143, v43, vcc
    v_cndmask_b32 v144, v144, v44, vcc
    v_cndmask_b32 v145, v145, v45, vcc
    v_cndmask_b32 v146, v146, v46, vcc
    v_cndmask_b32 v147, v147, v47, vcc
    s_mul_i32 s43, s47, 8704
    s_and_b32 s42, s14, 1
    s_lshl_b32 s42, s42, 7
    s_add_u32 s42, s42, s43
    v_mul_u32_u24 v176, 272, v1
    v_lshlrev_b32 v177, 3, v2
    v_add_u32 v176, v176, v177
    v_add_u32 v176, s42, v176
    v_cvt_pk_bf16_f32 v68, v68, v69
    v_cvt_pk_bf16_f32 v69, v70, v71
    ds_write_b64 v176, v[68:69] offset:0
    v_cvt_pk_bf16_f32 v72, v72, v73
    v_cvt_pk_bf16_f32 v73, v74, v75
    ds_write_b64 v176, v[72:73] offset:16
    v_cvt_pk_bf16_f32 v76, v76, v77
    v_cvt_pk_bf16_f32 v77, v78, v79
    ds_write_b64 v176, v[76:77] offset:32
    v_cvt_pk_bf16_f32 v80, v80, v81
    v_cvt_pk_bf16_f32 v81, v82, v83
    ds_write_b64 v176, v[80:81] offset:48
    v_cvt_pk_bf16_f32 v84, v84, v85
    v_cvt_pk_bf16_f32 v85, v86, v87
    ds_write_b64 v176, v[84:85] offset:19584
    v_cvt_pk_bf16_f32 v88, v88, v89
    v_cvt_pk_bf16_f32 v89, v90, v91
    ds_write_b64 v176, v[88:89] offset:19600
    v_cvt_pk_bf16_f32 v92, v92, v93
    v_cvt_pk_bf16_f32 v93, v94, v95
    ds_write_b64 v176, v[92:93] offset:19616
    v_cvt_pk_bf16_f32 v96, v96, v97
    v_cvt_pk_bf16_f32 v97, v98, v99
    ds_write_b64 v176, v[96:97] offset:19632
    v_cvt_pk_bf16_f32 v100, v100, v101
    v_cvt_pk_bf16_f32 v101, v102, v103
    ds_write_b64 v176, v[100:101] offset:64
    v_cvt_pk_bf16_f32 v104, v104, v105
    v_cvt_pk_bf16_f32 v105, v106, v107
    ds_write_b64 v176, v[104:105] offset:80
    v_cvt_pk_bf16_f32 v108, v108, v109
    v_cvt_pk_bf16_f32 v109, v110, v111
    ds_write_b64 v176, v[108:109] offset:96
    v_cvt_pk_bf16_f32 v112, v112, v113
    v_cvt_pk_bf16_f32 v113, v114, v115
    ds_write_b64 v176, v[112:113] offset:112
    v_cvt_pk_bf16_f32 v116, v116, v117
    v_cvt_pk_bf16_f32 v117, v118, v119
    ds_write_b64 v176, v[116:117] offset:19648
    v_cvt_pk_bf16_f32 v120, v120, v121
    v_cvt_pk_bf16_f32 v121, v122, v123
    ds_write_b64 v176, v[120:121] offset:19664
    v_cvt_pk_bf16_f32 v124, v124, v125
    v_cvt_pk_bf16_f32 v125, v126, v127
    ds_write_b64 v176, v[124:125] offset:19680
    v_cvt_pk_bf16_f32 v128, v128, v129
    v_cvt_pk_bf16_f32 v129, v130, v131
    ds_write_b64 v176, v[128:129] offset:19696
    v_add_u32 v178, 64, v1
    v_add_u32 v179, 128, v1
    v_cmp_gt_u32 vcc, 8, v1
    s_nop 1
    v_cndmask_b32 v178, v179, v178, vcc
    v_cmp_gt_u32 vcc, 16, v1
    v_mov_b32 v179, 146
    s_nop 0
    v_cndmask_b32 v178, v179, v178, vcc
    v_mul_u32_u24 v176, 272, v178
    v_lshlrev_b32 v177, 3, v2
    v_add_u32 v176, v176, v177
    s_lshl_b32 s42, s45, 6
    v_add_u32 v176, s42, v176
    v_cvt_pk_bf16_f32 v132, v132, v133
    v_cvt_pk_bf16_f32 v133, v134, v135
    ds_write_b64 v176, v[132:133] offset:0
    v_cvt_pk_bf16_f32 v136, v136, v137
    v_cvt_pk_bf16_f32 v137, v138, v139
    ds_write_b64 v176, v[136:137] offset:16
    v_cvt_pk_bf16_f32 v140, v140, v141
    v_cvt_pk_bf16_f32 v141, v142, v143
    ds_write_b64 v176, v[140:141] offset:32
    v_cvt_pk_bf16_f32 v144, v144, v145
    v_cvt_pk_bf16_f32 v145, v146, v147
    ds_write_b64 v176, v[144:145] offset:48
proj_kvout:
    s_waitcnt lgkmcnt(0)
    s_barrier
    s_cmp_ge_u32 s14, 4
    s_cbranch_scc0 proj_p2
    s_waitcnt vmcnt(0)
    v_readfirstlane_b32 s99, v194
    s_nop 3
    s_cmp_ge_u32 s99, 4
    s_cbranch_scc1 proj_vm7
    s_load_dwordx2 s[42:43], s[0:1], 80
    s_waitcnt lgkmcnt(0)
    s_mov_b32 s28, s42
    s_and_b32 s29, s43, 0xffff
    s_mov_b32 s30, 256
    s_mov_b32 s31, 0x20000
    v_mov_b32 v191, 0
    s_mov_b32 s98, 0
proj_mk8:
    buffer_load_dword v190, v191, s[28:31], 0 offen sc1
    s_waitcnt vmcnt(0)
    v_readfirstlane_b32 s99, v190
    s_nop 3
    s_cmp_ge_u32 s99, 4
    s_cbranch_scc1 proj_mk8_ok
    s_add_u32 s98, s98, 1
    s_cmp_lt_u32 s98, 0x40000
    s_cbranch_scc0 proj_mk8_ok
    s_sleep 2
    s_branch proj_mk8
proj_mk8_ok:
proj_vm7:
    s_mul_i32 s42, s15, 18
    v_add_u32 v176, s42, v1
    v_mul_u32_u24 v176, 272, v176
    v_lshlrev_b32 v177, 4, v2
    v_add_u32 v176, v176, v177
    s_add_u32 s42, s42, 72
    v_add_u32 v178, s42, v1
    v_mov_b32 v179, 144
    v_cmp_gt_u32 vcc, 18, v1
    s_nop 1
    v_cndmask_b32 v178, v179, v178, vcc
    v_mul_u32_u24 v178, 272, v178
    v_add_u32 v178, v178, v177
    ds_read_b128 v[8:11], v176 offset:0
    ds_read_b128 v[12:15], v178 offset:0
    ds_read_b128 v[16:19], v176 offset:32
    ds_read_b128 v[20:23], v178 offset:32
    ds_read_b128 v[24:27], v176 offset:64
    ds_read_b128 v[28:31], v178 offset:64
    ds_read_b128 v[32:35], v176 offset:96
    ds_read_b128 v[36:39], v178 offset:96
    ds_read_b128 v[40:43], v176 offset:128
    ds_read_b128 v[44:47], v178 offset:128
    ds_read_b128 v[48:51], v176 offset:160
    ds_read_b128 v[52:55], v178 offset:160
    ds_read_b128 v[56:59], v176 offset:192
    ds_read_b128 v[60:63], v178 offset:192
    ds_read_b128 v[64:67], v176 offset:224
    ds_read_b128 v[68:71], v178 offset:224
    s_waitcnt lgkmcnt(14)
    v_mfma_f32_32x32x16_bf16 v[80:95], v[8:11], v[12:15], 0
    s_waitcnt lgkmcnt(12)
    v_mfma_f32_32x32x16_bf16 v[80:95], v[16:19], v[20:23], v[80:95]
    s_waitcnt lgkmcnt(10)
    v_mfma_f32_32x32x16_bf16 v[80:95], v[24:27], v[28:31], v[80:95]
    s_waitcnt lgkmcnt(8)
    v_mfma_f32_32x32x16_bf16 v[80:95], v[32:35], v[36:39], v[80:95]
    s_waitcnt lgkmcnt(6)
    v_mfma_f32_32x32x16_bf16 v[80:95], v[40:43], v[44:47], v[80:95]
    s_waitcnt lgkmcnt(4)
    v_mfma_f32_32x32x16_bf16 v[80:95], v[48:51], v[52:55], v[80:95]
    s_waitcnt lgkmcnt(2)
    v_mfma_f32_32x32x16_bf16 v[80:95], v[56:59], v[60:63], v[80:95]
    s_waitcnt lgkmcnt(0)
    v_mfma_f32_32x32x16_bf16 v[80:95], v[64:67], v[68:71], v[80:95]
    s_sub_u32 s42, s13, 8
    s_lshl_b32 s100, s42, 7
    s_add_u32 s100, s100, 41984
    s_lshl_b32 s42, s42, 2
    s_add_u32 s42, s42, s15
    s_mul_i32 s42, s42, 2560
    s_add_u32 s42, s42, 4980736
    v_lshlrev_b32 v180, 2, v0
    v_mov_b32 v181, 2146435072
    v_cmp_gt_u32 vcc, 19, v1
    s_nop 1
    v_cndmask_b32 v182, v181, v180, vcc
    v_cmp_gt_u32 vcc, 19, v0
    s_nop 1
    v_cndmask_b32 v183, v181, v180, vcc
    s_nop 7
    s_nop 3
    buffer_atomic_add_f32 v80, v182, s[32:35], s42 offen offset:0
    buffer_atomic_add_f32 v81, v182, s[32:35], s42 offen offset:256
    buffer_atomic_add_f32 v82, v182, s[32:35], s42 offen offset:512
    buffer_atomic_add_f32 v83, v182, s[32:35], s42 offen offset:768
    buffer_atomic_add_f32 v84, v182, s[32:35], s42 offen offset:1024
    buffer_atomic_add_f32 v85, v182, s[32:35], s42 offen offset:1280
    buffer_atomic_add_f32 v86, v182, s[32:35], s42 offen offset:1536
    buffer_atomic_add_f32 v87, v182, s[32:35], s42 offen offset:1792
    buffer_atomic_add_f32 v88, v183, s[32:35], s42 offen offset:2048
    buffer_atomic_add_f32 v89, v183, s[32:35], s42 offen offset:2304
    s_branch proj_p2
proj_bsetup:
    v_mul_lo_u32 v196, v0, s49
    v_add_u32 v196, s48, v196
    s_mul_i32 s42, s16, s36
    buffer_load_dword v197, v196, s[24:27], s42 offen
    s_mov_b32 s32, s56
    s_and_b32 s33, s57, 0xffff
    s_mov_b32 s34, 16777216
    s_mov_b32 s35, 0x20000
    s_cmp_eq_u32 s2, 200
    s_cbranch_scc0 proj_nozero
    v_mov_b32 v8, 0
    v_mov_b32 v9, 0
    v_mov_b32 v10, 0
    v_mov_b32 v11, 0
    v_lshlrev_b32 v176, 4, v0
    s_mul_i32 s42, s15, 14336
    s_add_u32 s42, s42, 7208960
    buffer_store_dwordx4 v[8:11], v176, s[32:35], s42 offen offset:0 sc1
    buffer_store_dwordx4 v[8:11], v176, s[32:35], s42 offen offset:1024 sc1
    buffer_store_dwordx4 v[8:11], v176, s[32:35], s42 offen offset:2048 sc1
    buffer_store_dwordx4 v[8:11], v176, s[32:35], s42 offen offset:3072 sc1
    s_add_u32 s42, s42, 4096
    buffer_store_dwordx4 v[8:11], v176, s[32:35], s42 offen offset:0 sc1
    buffer_store_dwordx4 v[8:11], v176, s[32:35], s42 offen offset:1024 sc1
    buffer_store_dwordx4 v[8:11], v176, s[32:35], s42 offen offset:2048 sc1
    buffer_store_dwordx4 v[8:11], v176, s[32:35], s42 offen offset:3072 sc1
    s_add_u32 s42, s42, 4096
    buffer_store_dwordx4 v[8:11], v176, s[32:35], s42 offen offset:0 sc1
    buffer_store_dwordx4 v[8:11], v176, s[32:35], s42 offen offset:1024 sc1
    buffer_store_dwordx4 v[8:11], v176, s[32:35], s42 offen offset:2048 sc1
    buffer_store_dwordx4 v[8:11], v176, s[32:35], s42 offen offset:3072 sc1
    s_add_u32 s42, s42, 4096
    buffer_store_dwordx4 v[8:11], v176, s[32:35], s42 offen offset:0 sc1
    buffer_store_dwordx4 v[8:11], v176, s[32:35], s42 offen offset:1024 sc1
    s_mul_i32 s42, s15, 20480
    s_add_u32 s42, s42, 4980736
    buffer_store_dwordx4 v[8:11], v176, s[32:35], s42 offen offset:0 sc1
    buffer_store_dwordx4 v[8:11], v176, s[32:35], s42 offen offset:1024 sc1
    buffer_store_dwordx4 v[8:11], v176, s[32:35], s42 offen offset:2048 sc1
    buffer_store_dwordx4 v[8:11], v176, s[32:35], s42 offen offset:3072 sc1
    s_add_u32 s42, s42, 4096
    buffer_store_dwordx4 v[8:11], v176, s[32:35], s42 offen offset:0 sc1
    buffer_store_dwordx4 v[8:11], v176, s[32:35], s42 offen offset:1024 sc1
    buffer_store_dwordx4 v[8:11], v176, s[32:35], s42 offen offset:2048 sc1
    buffer_store_dwordx4 v[8:11], v176, s[32:35], s42 offen offset:3072 sc1
    s_add_u32 s42, s42, 4096
    buffer_store_dwordx4 v[8:11], v176, s[32:35], s42 offen offset:0 sc1
    buffer_store_dwordx4 v[8:11], v176, s[32:35], s42 offen offset:1024 sc1
    buffer_store_dwordx4 v[8:11], v176, s[32:35], s42 offen offset:2048 sc1
    buffer_store_dwordx4 v[8:11], v176, s[32:35], s42 offen offset:3072 sc1
    s_add_u32 s42, s42, 4096
    buffer_store_dwordx4 v[8:11], v176, s[32:35], s42 offen offset:0 sc1
    buffer_store_dwordx4 v[8:11], v176, s[32:35], s42 offen offset:1024 sc1
    buffer_store_dwordx4 v[8:11], v176, s[32:35], s42 offen offset:2048 sc1
    buffer_store_dwordx4 v[8:11], v176, s[32:35], s42 offen offset:3072 sc1
    s_add_u32 s42, s42, 4096
    buffer_store_dwordx4 v[8:11], v176, s[32:35], s42 offen offset:0 sc1
    buffer_store_dwordx4 v[8:11], v176, s[32:35], s42 offen offset:1024 sc1
    buffer_store_dwordx4 v[8:11], v176, s[32:35], s42 offen offset:2048 sc1
    buffer_store_dwordx4 v[8:11], v176, s[32:35], s42 offen offset:3072 sc1
    s_add_u32 s42, s42, 4096
    s_waitcnt vmcnt(0)
    s_load_dwordx2 s[42:43], s[0:1], 80
    s_waitcnt lgkmcnt(0)
    s_mov_b32 s28, s42
    s_and_b32 s29, s43, 0xffff
    s_mov_b32 s30, 256
    s_mov_b32 s31, 0x20000
    v_mov_b32 v8, 1
    v_mov_b32 v9, 2146435072
    v_cmp_eq_u32 vcc, 0, v0
    s_nop 1
    v_cndmask_b32 v9, v9, v11, vcc
    buffer_atomic_add v8, v9, s[28:31], 0 offen sc1
proj_nozero:
    s_add_u32 s45, s15, 0
    s_lshl_b32 s44, s45, 6
    v_add_u32 v183, s44, v0
    v_mul_u32_u24 v184, 3641, v183
    v_lshrrev_b32 v184, 16, v184
    v_mul_u32_u24 v185, 18, v184
    v_sub_u32 v185, v183, v185
    v_lshlrev_b32 v186, 1, v184
    v_sub_u32 v186, v185, v186
    v_and_b32 v186, 15, v186
    v_cmp_gt_u32 vcc, 16, v185
    s_nop 1
    v_cndmask_b32 v185, v185, v186, vcc
    s_cmp_eq_u32 s50, 0
    s_cbranch_scc1 proj_wq4
    v_and_b32 v186, 7, v185
    v_lshrrev_b32 v187, 3, v185
    v_cmp_lt_u32 vcc, 15, v185
    v_and_b32 v188, 1, v185
    v_mov_b32 v189, 8
    v_cndmask_b32 v186, v186, v189, vcc
    v_cndmask_b32 v187, v187, v188, vcc
    v_mul_u32_u24 v187, 72, v187
    v_add_u32 v185, v186, v187
proj_wq4:
    v_lshlrev_b32 v185, 4, v185
    v_mul_lo_u32 v184, v184, s49
    v_add_u32 v185, v185, v184
    v_add_u32 v4, s48, v185
    s_add_u32 s45, s15, 4
    s_lshl_b32 s44, s45, 6
    v_add_u32 v183, s44, v0
    v_mul_u32_u24 v184, 3641, v183
    v_lshrrev_b32 v184, 16, v184
    v_mul_u32_u24 v185, 18, v184
    v_sub_u32 v185, v183, v185
    v_lshlrev_b32 v186, 1, v184
    v_sub_u32 v186, v185, v186
    v_and_b32 v186, 15, v186
    v_cmp_gt_u32 vcc, 16, v185
    s_nop 1
    v_cndmask_b32 v185, v185, v186, vcc
    s_cmp_eq_u32 s50, 0
    s_cbranch_scc1 proj_wq5
    v_and_b32 v186, 7, v185
    v_lshrrev_b32 v187, 3, v185
    v_cmp_lt_u32 vcc, 15, v185
    v_and_b32 v188, 1, v185
    v_mov_b32 v189, 8
    v_cndmask_b32 v186, v186, v189, vcc
    v_cndmask_b32 v187, v187, v188, vcc
    v_mul_u32_u24 v187, 72, v187
    v_add_u32 v185, v186, v187
proj_wq5:
    v_lshlrev_b32 v185, 4, v185
    v_mul_lo_u32 v184, v184, s49
    v_add_u32 v185, v185, v184
    v_add_u32 v5, s48, v185
    s_add_u32 s45, s15, 8
    s_lshl_b32 s44, s45, 6
    v_add_u32 v183, s44, v0
    v_mul_u32_u24 v184, 3641, v183
    v_lshrrev_b32 v184, 16, v184
    v_mul_u32_u24 v185, 18, v184
    v_sub_u32 v185, v183, v185
    v_lshlrev_b32 v186, 1, v184
    v_sub_u32 v186, v185, v186
    v_and_b32 v186, 15, v186
    v_cmp_gt_u32 vcc, 16, v185
    s_nop 1
    v_cndmask_b32 v185, v185, v186, vcc
    s_cmp_eq_u32 s50, 0
    s_cbranch_scc1 proj_wq6
    v_and_b32 v186, 7, v185
    v_lshrrev_b32 v187, 3, v185
    v_cmp_lt_u32 vcc, 15, v185
    v_and_b32 v188, 1, v185
    v_mov_b32 v189, 8
    v_cndmask_b32 v186, v186, v189, vcc
    v_cndmask_b32 v187, v187, v188, vcc
    v_mul_u32_u24 v187, 72, v187
    v_add_u32 v185, v186, v187
proj_wq6:
    v_lshlrev_b32 v185, 4, v185
    v_mul_lo_u32 v184, v184, s49
    v_add_u32 v185, v185, v184
    v_add_u32 v6, s48, v185
    s_add_u32 s45, s15, 12
    s_lshl_b32 s44, s45, 6
    v_add_u32 v183, s44, v0
    v_mul_u32_u24 v184, 3641, v183
    v_lshrrev_b32 v184, 16, v184
    v_mul_u32_u24 v185, 18, v184
    v_sub_u32 v185, v183, v185
    v_lshlrev_b32 v186, 1, v184
    v_sub_u32 v186, v185, v186
    v_and_b32 v186, 15, v186
    v_cmp_gt_u32 vcc, 16, v185
    s_nop 1
    v_cndmask_b32 v185, v185, v186, vcc
    s_cmp_eq_u32 s50, 0
    s_cbranch_scc1 proj_wq7
    v_and_b32 v186, 7, v185
    v_lshrrev_b32 v187, 3, v185
    v_cmp_lt_u32 vcc, 15, v185
    v_and_b32 v188, 1, v185
    v_mov_b32 v189, 8
    v_cndmask_b32 v186, v186, v189, vcc
    v_cndmask_b32 v187, v187, v188, vcc
    v_mul_u32_u24 v187, 72, v187
    v_add_u32 v185, v186, v187
proj_wq7:
    v_lshlrev_b32 v185, 4, v185
    v_mul_lo_u32 v184, v184, s49
    v_add_u32 v185, v185, v184
    v_add_u32 v7, s48, v185
    s_add_u32 s45, s15, 16
    s_lshl_b32 s44, s45, 6
    v_add_u32 v183, s44, v0
    v_mul_u32_u24 v184, 3641, v183
    v_lshrrev_b32 v184, 16, v184
    v_mul_u32_u24 v185, 18, v184
    v_sub_u32 v185, v183, v185
    v_lshlrev_b32 v186, 1, v184
    v_sub_u32 v186, v185, v186
    v_and_b32 v186, 15, v186
    v_cmp_gt_u32 vcc, 16, v185
    s_nop 1
    v_cndmask_b32 v185, v185, v186, vcc
    s_cmp_eq_u32 s50, 0
    s_cbranch_scc1 proj_wq148
    v_and_b32 v186, 7, v185
    v_lshrrev_b32 v187, 3, v185
    v_cmp_lt_u32 vcc, 15, v185
    v_and_b32 v188, 1, v185
    v_mov_b32 v189, 8
    v_cndmask_b32 v186, v186, v189, vcc
    v_cndmask_b32 v187, v187, v188, vcc
    v_mul_u32_u24 v187, 72, v187
    v_add_u32 v185, v186, v187
proj_wq148:
    v_lshlrev_b32 v185, 4, v185
    v_mul_lo_u32 v184, v184, s49
    v_add_u32 v185, v185, v184
    v_add_u32 v148, s48, v185
    s_mov_b32 s28, s24
    s_mov_b32 s29, s25
    s_mov_b32 s30, s26
    s_mov_b32 s31, 0x20000
    s_mov_b32 s37, s36
    s_cmp_lt_u32 s15, 2
    s_cbranch_scc1 proj_b9done
    s_sub_u32 s42, s15, 2
    s_lshl_b32 s42, s42, 5
    v_lshrrev_b32 v183, 1, v0
    v_add_u32 v183, s42, v183
    v_and_b32 v184, 1, v0
    s_cmp_eq_u32 s13, 2
    s_cbranch_scc1 proj_bgate
    s_cmp_ge_u32 s13, 8
    s_cselect_b32 s28, s10, s8
    s_cselect_b32 s42, s11, s9
    s_and_b32 s29, s42, 0xffff
    s_and_b32 s42, s13, 6
    s_cmp_eq_u32 s42, 0
    s_cselect_b32 s30, 20736, 0
    s_movk_i32 s37, 2304
    v_mul_u32_u24 v183, 36, v183
    v_lshlrev_b32 v184, 4, v184
    v_add_u32 v183, v183, v184
    s_and_b32 s42, s13, 1
    s_lshl_b32 s42, s42, 5
    v_add_u32 v148, s42, v183
    s_branch proj_b9done
proj_bgate:
    s_mov_b32 s28, s54
    s_and_b32 s29, s55, 0xffff
    s_movk_i32 s30, 1152
    s_movk_i32 s37, 128
    v_and_b32 v185, 1, v183
    v_cmp_eq_u32 vcc, v185, v184
    v_and_b32 v183, 0xfffffffe, v183
    v_lshlrev_b32 v183, 1, v183
    v_mov_b32 v184, 2146435072
    v_cndmask_b32 v148, v184, v183, vcc
proj_b9done:
    s_mov_b32 s17, s16
    s_mul_i32 s39, s17, s36
    s_mul_i32 s40, s17, s37
    s_add_u32 m0, s41, 65536
    s_nop 0
    buffer_load_dwordx4 v4, s[24:27], s39 offen lds
    s_add_u32 m0, s41, 69632
    s_nop 0
    buffer_load_dwordx4 v5, s[24:27], s39 offen lds
    s_add_u32 m0, s41, 73728
    s_nop 0
    buffer_load_dwordx4 v6, s[24:27], s39 offen lds
    s_add_u32 m0, s41, 77824
    s_nop 0
    buffer_load_dwordx4 v7, s[24:27], s39 offen lds
    s_add_u32 m0, s41, 81920
    s_nop 0
    buffer_load_dwordx4 v148, s[28:31], s40 offen lds
    s_add_u32 s17, s17, 1
    s_cmp_eq_u32 s17, 9
    s_cselect_b32 s17, 0, s17
    s_lshl_b32 s38, s17, 7
    s_add_u32 m0, s41, 16384
    s_add_u32 s42, s38, 0
    buffer_load_dwordx4 v3, s[20:23], s42 offen lds
    s_add_u32 m0, s41, 20480
    s_add_u32 s42, s38, 36864
    buffer_load_dwordx4 v3, s[20:23], s42 offen lds
    s_add_u32 m0, s41, 24576
    s_add_u32 s42, s38, 73728
    buffer_load_dwordx4 v3, s[20:23], s42 offen lds
    s_add_u32 m0, s41, 28672
    s_add_u32 s42, s38, 110592
    buffer_load_dwordx4 v3, s[20:23], s42 offen lds
    s_mul_i32 s39, s17, s36
    s_mul_i32 s40, s17, s37
    s_add_u32 m0, s41, 86016
    s_nop 0
    buffer_load_dwordx4 v4, s[24:27], s39 offen lds
    s_add_u32 m0, s41, 90112
    s_nop 0
    buffer_load_dwordx4 v5, s[24:27], s39 offen lds
    s_add_u32 m0, s41, 94208
    s_nop 0
    buffer_load_dwordx4 v6, s[24:27], s39 offen lds
    s_add_u32 m0, s41, 98304
    s_nop 0
    buffer_load_dwordx4 v7, s[24:27], s39 offen lds
    s_add_u32 m0, s41, 102400
    s_nop 0
    buffer_load_dwordx4 v148, s[28:31], s40 offen lds
    s_add_u32 s17, s17, 1
    s_cmp_eq_u32 s17, 9
    s_cselect_b32 s17, 0, s17
    s_waitcnt vmcnt(9)
    s_barrier
    s_lshl_b32 s38, s17, 7
    s_add_u32 m0, s41, 32768
    s_add_u32 s42, s38, 0
    buffer_load_dwordx4 v3, s[20:23], s42 offen lds
    s_add_u32 m0, s41, 36864
    s_add_u32 s42, s38, 36864
    buffer_load_dwordx4 v3, s[20:23], s42 offen lds
    s_add_u32 m0, s41, 40960
    s_add_u32 s42, s38, 73728
    buffer_load_dwordx4 v3, s[20:23], s42 offen lds
    s_add_u32 m0, s41, 45056
    s_add_u32 s42, s38, 110592
    buffer_load_dwordx4 v3, s[20:23], s42 offen lds
    s_mul_i32 s39, s17, s36
    s_mul_i32 s40, s17, s37
    s_add_u32 m0, s41, 106496
    s_nop 0
    buffer_load_dwordx4 v4, s[24:27], s39 offen lds
    s_add_u32 m0, s41, 110592
    s_nop 0
    buffer_load_dwordx4 v5, s[24:27], s39 offen lds
    s_add_u32 m0, s41, 114688
    s_nop 0
    buffer_load_dwordx4 v6, s[24:27], s39 offen lds
    s_add_u32 m0, s41, 118784
    s_nop 0
    buffer_load_dwordx4 v7, s[24:27], s39 offen lds
    s_add_u32 m0, s41, 122880
    s_nop 0
    buffer_load_dwordx4 v148, s[28:31], s40 offen lds
    s_add_u32 s17, s17, 1
    s_cmp_eq_u32 s17, 9
    s_cselect_b32 s17, 0, s17
    s_lshl_b32 s38, s17, 7
    s_add_u32 m0, s41, 49152
    s_add_u32 s42, s38, 0
    buffer_load_dwordx4 v3, s[20:23], s42 offen lds
    s_add_u32 m0, s41, 53248
    s_add_u32 s42, s38, 36864
    buffer_load_dwordx4 v3, s[20:23], s42 offen lds
    s_add_u32 m0, s41, 57344
    s_add_u32 s42, s38, 73728
    buffer_load_dwordx4 v3, s[20:23], s42 offen lds
    s_add_u32 m0, s41, 61440
    s_add_u32 s42, s38, 110592
    buffer_load_dwordx4 v3, s[20:23], s42 offen lds
    s_mul_i32 s39, s17, s36
    s_mul_i32 s40, s17, s37
    s_add_u32 m0, s41, 126976
    s_nop 0
    buffer_load_dwordx4 v4, s[24:27], s39 offen lds
    s_add_u32 m0, s41, 131072
    s_nop 0
    buffer_load_dwordx4 v5, s[24:27], s39 offen lds
    s_add_u32 m0, s41, 135168
    s_nop 0
    buffer_load_dwordx4 v6, s[24:27], s39 offen lds
    s_add_u32 m0, s41, 139264
    s_nop 0
    buffer_load_dwordx4 v7, s[24:27], s39 offen lds
    s_add_u32 m0, s41, 143360
    s_nop 0
    buffer_load_dwordx4 v148, s[28:31], s40 offen lds
    s_add_u32 s17, s17, 1
    s_cmp_eq_u32 s17, 9
    s_cselect_b32 s17, 0, s17
    s_mul_i32 s42, s2, 911
    s_lshr_b32 s42, s42, 16
    s_mul_i32 s43, s42, 72
    s_sub_u32 s43, s2, s43
    s_mul_i32 s44, s43, 7282
    s_lshr_b32 s44, s44, 16
    s_mul_i32 s45, s44, 9
    s_sub_u32 s45, s43, s45
    s_lshl_b32 s62, s45, 2
    s_add_u32 s62, s62, s15
    s_lshl_b32 s51, s42, 3
    s_add_u32 s51, s51, s44
    s_mul_i32 s51, s51, 36
    s_add_u32 s51, s51, s62
    s_mul_i32 s51, s51, 2304
    s_add_u32 s51, s51, 5832704
    s_cmp_eq_u32 s42, 0
    s_cselect_b32 s8, s58, s60
    s_cselect_b32 s46, s59, s61
    s_and_b32 s9, s46, 0xffff
    s_cmp_lt_u32 s2, 144
    s_cselect_b32 s10, 663552, 0
    s_mov_b32 s11, 0x20000
    s_mul_i32 s44, s44, 144
    v_add_u32 v183, 0, v0
    v_mul_u32_u24 v184, 7282, v183
    v_lshrrev_b32 v184, 16, v184
    v_mul_u32_u24 v185, 9, v184
    v_sub_u32 v185, v183, v185
    v_lshlrev_b32 v185, 4, v185
    s_mul_i32 s42, s62, 18
    v_add_u32 v186, s42, v184
    s_sub_u32 s42, s62, 32
    s_lshl_b32 s42, s42, 3
    v_lshrrev_b32 v187, 1, v184
    v_add_u32 v187, s42, v187
    v_mul_u32_u24 v187, 18, v187
    v_and_b32 v188, 1, v184
    v_add_u32 v187, v187, v188
    v_add_u32 v187, 16, v187
    s_cmp_lt_u32 s62, 32
    s_cselect_b64 vcc, -1, 0
    v_cndmask_b32 v186, v187, v186, vcc
    v_mul_u32_u24 v186, 1152, v186
    v_add_u32 v186, v186, v185
    v_add_u32 v186, s44, v186
    v_cmp_gt_u32 vcc, 16, v184
    v_mov_b32 v187, 2146435072
    s_nop 0
    v_cndmask_b32 v186, v187, v186, vcc
    s_mul_i32 s42, s15, 2560
    s_add_u32 m0, s42, 147456
    s_nop 0
    buffer_load_dwordx4 v186, s[8:11], 0 offen lds
    v_add_u32 v183, 64, v0
    v_mul_u32_u24 v184, 7282, v183
    v_lshrrev_b32 v184, 16, v184
    v_mul_u32_u24 v185, 9, v184
    v_sub_u32 v185, v183, v185
    v_lshlrev_b32 v185, 4, v185
    s_mul_i32 s42, s62, 18
    v_add_u32 v186, s42, v184
    s_sub_u32 s42, s62, 32
    s_lshl_b32 s42, s42, 3
    v_lshrrev_b32 v187, 1, v184
    v_add_u32 v187, s42, v187
    v_mul_u32_u24 v187, 18, v187
    v_and_b32 v188, 1, v184
    v_add_u32 v187, v187, v188
    v_add_u32 v187, 16, v187
    s_cmp_lt_u32 s62, 32
    s_cselect_b64 vcc, -1, 0
    v_cndmask_b32 v186, v187, v186, vcc
    v_mul_u32_u24 v186, 1152, v186
    v_add_u32 v186, v186, v185
    v_add_u32 v186, s44, v186
    v_cmp_gt_u32 vcc, 16, v184
    v_mov_b32 v187, 2146435072
    s_nop 0
    v_cndmask_b32 v186, v187, v186, vcc
    s_mul_i32 s42, s15, 2560
    s_add_u32 m0, s42, 148480
    s_nop 0
    buffer_load_dwordx4 v186, s[8:11], 0 offen lds
    v_add_u32 v183, 128, v0
    v_mul_u32_u24 v184, 7282, v183
    v_lshrrev_b32 v184, 16, v184
    v_mul_u32_u24 v185, 9, v184
    v_sub_u32 v185, v183, v185
    v_lshlrev_b32 v185, 4, v185
    s_mul_i32 s42, s62, 18
    v_add_u32 v186, s42, v184
    s_sub_u32 s42, s62, 32
    s_lshl_b32 s42, s42, 3
    v_lshrrev_b32 v187, 1, v184
    v_add_u32 v187, s42, v187
    v_mul_u32_u24 v187, 18, v187
    v_and_b32 v188, 1, v184
    v_add_u32 v187, v187, v188
    v_add_u32 v187, 16, v187
    s_cmp_lt_u32 s62, 32
    s_cselect_b64 vcc, -1, 0
    v_cndmask_b32 v186, v187, v186, vcc
    v_mul_u32_u24 v186, 1152, v186
    v_add_u32 v186, v186, v185
    v_add_u32 v186, s44, v186
    v_cmp_gt_u32 vcc, 16, v184
    v_mov_b32 v187, 2146435072
    s_nop 0
    v_cndmask_b32 v186, v187, v186, vcc
    s_mul_i32 s42, s15, 2560
    s_add_u32 m0, s42, 149504
    s_nop 0
    s_mov_b32 exec_hi, 0
    s_mov_b32 exec_lo, 0xffff
    buffer_load_dwordx4 v186, s[8:11], 0 offen lds
    s_mov_b64 exec, -1
    s_waitcnt vmcnt(21)
    s_barrier
    s_lshl_b32 s38, s17, 7
    s_add_u32 m0, s41, 0
    s_add_u32 s42, s38, 0
    buffer_load_dwordx4 v3, s[20:23], s42 offen lds
    s_add_u32 m0, s41, 4096
    s_add_u32 s42, s38, 36864
    buffer_load_dwordx4 v3, s[20:23], s42 offen lds
    s_add_u32 m0, s41, 8192
    s_add_u32 s42, s38, 73728
    buffer_load_dwordx4 v3, s[20:23], s42 offen lds
    s_add_u32 m0, s41, 12288
    s_add_u32 s42, s38, 110592
    buffer_load_dwordx4 v3, s[20:23], s42 offen lds
    s_mul_i32 s39, s17, s36
    s_mul_i32 s40, s17, s37
    s_add_u32 m0, s41, 65536
    s_nop 0
    buffer_load_dwordx4 v4, s[24:27], s39 offen lds
    s_add_u32 m0, s41, 69632
    s_nop 0
    buffer_load_dwordx4 v5, s[24:27], s39 offen lds
    s_add_u32 m0, s41, 73728
    s_nop 0
    buffer_load_dwordx4 v6, s[24:27], s39 offen lds
    s_add_u32 m0, s41, 77824
    s_nop 0
    buffer_load_dwordx4 v7, s[24:27], s39 offen lds
    s_add_u32 m0, s41, 81920
    s_nop 0
    buffer_load_dwordx4 v148, s[28:31], s40 offen lds
    s_add_u32 s17, s17, 1
    s_cmp_eq_u32 s17, 9
    s_cselect_b32 s17, 0, s17
    s_waitcnt vmcnt(21)
    s_barrier
    s_lshl_b32 s38, s17, 7
    s_add_u32 m0, s41, 16384
    s_add_u32 s42, s38, 0
    buffer_load_dwordx4 v3, s[20:23], s42 offen lds
    s_add_u32 m0, s41, 20480
    s_add_u32 s42, s38, 36864
    buffer_load_dwordx4 v3, s[20:23], s42 offen lds
    s_add_u32 m0, s41, 24576
    s_add_u32 s42, s38, 73728
    buffer_load_dwordx4 v3, s[20:23], s42 offen lds
    s_add_u32 m0, s41, 28672
    s_add_u32 s42, s38, 110592
    buffer_load_dwordx4 v3, s[20:23], s42 offen lds
    s_mul_i32 s39, s17, s36
    s_mul_i32 s40, s17, s37
    s_add_u32 m0, s41, 86016
    s_nop 0
    buffer_load_dwordx4 v4, s[24:27], s39 offen lds
    s_add_u32 m0, s41, 90112
    s_nop 0
    buffer_load_dwordx4 v5, s[24:27], s39 offen lds
    s_add_u32 m0, s41, 94208
    s_nop 0
    buffer_load_dwordx4 v6, s[24:27], s39 offen lds
    s_add_u32 m0, s41, 98304
    s_nop 0
    buffer_load_dwordx4 v7, s[24:27], s39 offen lds
    s_add_u32 m0, s41, 102400
    s_nop 0
    buffer_load_dwordx4 v148, s[28:31], s40 offen lds
    s_add_u32 s17, s17, 1
    s_cmp_eq_u32 s17, 9
    s_cselect_b32 s17, 0, s17
    s_waitcnt vmcnt(21)
    s_barrier
    s_lshl_b32 s38, s17, 7
    s_add_u32 m0, s41, 32768
    s_add_u32 s42, s38, 0
    buffer_load_dwordx4 v3, s[20:23], s42 offen lds
    s_add_u32 m0, s41, 36864
    s_add_u32 s42, s38, 36864
    buffer_load_dwordx4 v3, s[20:23], s42 offen lds
    s_add_u32 m0, s41, 40960
    s_add_u32 s42, s38, 73728
    buffer_load_dwordx4 v3, s[20:23], s42 offen lds
    s_add_u32 m0, s41, 45056
    s_add_u32 s42, s38, 110592
    buffer_load_dwordx4 v3, s[20:23], s42 offen lds
    s_mul_i32 s39, s17, s36
    s_mul_i32 s40, s17, s37
    s_add_u32 m0, s41, 106496
    s_nop 0
    buffer_load_dwordx4 v4, s[24:27], s39 offen lds
    s_add_u32 m0, s41, 110592
    s_nop 0
    buffer_load_dwordx4 v5, s[24:27], s39 offen lds
    s_add_u32 m0, s41, 114688
    s_nop 0
    buffer_load_dwordx4 v6, s[24:27], s39 offen lds
    s_add_u32 m0, s41, 118784
    s_nop 0
    buffer_load_dwordx4 v7, s[24:27], s39 offen lds
    s_add_u32 m0, s41, 122880
    s_nop 0
    buffer_load_dwordx4 v148, s[28:31], s40 offen lds
    s_add_u32 s17, s17, 1
    s_cmp_eq_u32 s17, 9
    s_cselect_b32 s17, 0, s17
    s_waitcnt vmcnt(18)
    s_barrier
    s_lshl_b32 s38, s17, 7
    s_add_u32 m0, s41, 49152
    s_add_u32 s42, s38, 0
    buffer_load_dwordx4 v3, s[20:23], s42 offen lds
    s_add_u32 m0, s41, 53248
    s_add_u32 s42, s38, 36864
    buffer_load_dwordx4 v3, s[20:23], s42 offen lds
    s_add_u32 m0, s41, 57344
    s_add_u32 s42, s38, 73728
    buffer_load_dwordx4 v3, s[20:23], s42 offen lds
    s_add_u32 m0, s41, 61440
    s_add_u32 s42, s38, 110592
    buffer_load_dwordx4 v3, s[20:23], s42 offen lds
    s_mul_i32 s39, s17, s36
    s_mul_i32 s40, s17, s37
    s_add_u32 m0, s41, 126976
    s_nop 0
    buffer_load_dwordx4 v4, s[24:27], s39 offen lds
    s_add_u32 m0, s41, 131072
    s_nop 0
    buffer_load_dwordx4 v5, s[24:27], s39 offen lds
    s_add_u32 m0, s41, 135168
    s_nop 0
    buffer_load_dwordx4 v6, s[24:27], s39 offen lds
    s_add_u32 m0, s41, 139264
    s_nop 0
    buffer_load_dwordx4 v7, s[24:27], s39 offen lds
    s_add_u32 m0, s41, 143360
    s_nop 0
    buffer_load_dwordx4 v148, s[28:31], s40 offen lds
    s_add_u32 s17, s17, 1
    s_cmp_eq_u32 s17, 9
    s_cselect_b32 s17, 0, s17
    s_waitcnt vmcnt(18)
    s_barrier
    s_lshl_b32 s38, s17, 7
    s_add_u32 m0, s41, 0
    s_add_u32 s42, s38, 0
    buffer_load_dwordx4 v3, s[20:23], s42 offen lds
    s_add_u32 m0, s41, 4096
    s_add_u32 s42, s38, 36864
    buffer_load_dwordx4 v3, s[20:23], s42 offen lds
    s_add_u32 m0, s41, 8192
    s_add_u32 s42, s38, 73728
    buffer_load_dwordx4 v3, s[20:23], s42 offen lds
    s_add_u32 m0, s41, 12288
    s_add_u32 s42, s38, 110592
    buffer_load_dwordx4 v3, s[20:23], s42 offen lds
    s_mul_i32 s39, s17, s36
    s_mul_i32 s40, s17, s37
    s_add_u32 m0, s41, 65536
    s_nop 0
    buffer_load_dwordx4 v4, s[24:27], s39 offen lds
    s_add_u32 m0, s41, 69632
    s_nop 0
    buffer_load_dwordx4 v5, s[24:27], s39 offen lds
    s_add_u32 m0, s41, 73728
    s_nop 0
    buffer_load_dwordx4 v6, s[24:27], s39 offen lds
    s_add_u32 m0, s41, 77824
    s_nop 0
    buffer_load_dwordx4 v7, s[24:27], s39 offen lds
    s_add_u32 m0, s41, 81920
    s_nop 0
    buffer_load_dwordx4 v148, s[28:31], s40 offen lds
    s_add_u32 s17, s17, 1
    s_cmp_eq_u32 s17, 9
    s_cselect_b32 s17, 0, s17
    s_waitcnt vmcnt(18)
    s_barrier
    s_load_dwordx2 s[42:43], s[0:1], 80
    v_mov_b32 v195, 0
    s_waitcnt lgkmcnt(0)
    s_mov_b32 s28, s42
    s_and_b32 s29, s43, 0xffff
    s_mov_b32 s30, 256
    s_mov_b32 s31, 0x20000
    buffer_load_dword v194, v195, s[28:31], 0 offen sc1
    s_waitcnt vmcnt(10)
    s_barrier
    s_waitcnt vmcnt(0)
    s_barrier
    s_cmp_lt_u32 s2, 144
    s_cbranch_scc0 proj_nowof
    s_and_b32 s101, s2, 15
    s_lshl_b32 s101, s101, 7
    s_add_u32 s101, s101, 43008
    v_lshrrev_b32 v176, 4, v0
    v_and_b32 v176, 1, v176
    v_lshlrev_b32 v176, 5, v176
    v_lshrrev_b32 v177, 2, v0
    v_and_b32 v177, 3, v177
    v_lshlrev_b32 v178, 3, v2
    v_add_u32 v177, v177, v178
    v_mul_u32_u24 v177, 144, v177
    v_and_b32 v178, 3, v0
    v_lshlrev_b32 v178, 3, v178
    v_add_u32 v176, v176, v177
    v_add_u32 v176, v176, v178
    s_mul_i32 s42, s15, 2560
    s_add_u32 s42, s42, 147456
    v_add_u32 v176, s42, v176
    ds_read_b64_tr_b16 v[8:9], v176 offset:0
    ds_read_b64_tr_b16 v[10:11], v176 offset:576
    ds_read_b64_tr_b16 v[12:13], v176 offset:64
    ds_read_b64_tr_b16 v[14:15], v176 offset:640
    ds_read_b64_tr_b16 v[16:17], v176 offset:128
    ds_read_b64_tr_b16 v[18:19], v176 offset:704
    v_lshlrev_b32 v179, 4, v0
    v_lshlrev_b32 v180, 3, v2
    v_add_u32 v180, v180, v1
    v_lshlrev_b32 v180, 4, v180
    v_mov_b32 v181, 2146435072
    v_cmp_gt_u32 vcc, 8, v1
    s_nop 1
    v_cndmask_b32 v180, v181, v180, vcc
    s_waitcnt lgkmcnt(0)
    buffer_store_dwordx4 v[8:11], v179, s[32:35], s51 offen sc1
    buffer_store_dwordx4 v[12:15], v179, s[32:35], s51 offen offset:1024 sc1
    buffer_store_dwordx4 v[16:19], v180, s[32:35], s51 offen offset:2048 sc1
proj_nowof:
    s_barrier
    s_cmp_eq_u32 s14, 4
    s_cbranch_scc0 proj_nobs
    s_and_b32 s42, s13, 14
    s_cmp_eq_u32 s42, 8
    s_cbranch_scc0 proj_nobs
    s_waitcnt vmcnt(0)
    v_readfirstlane_b32 s99, v194
    s_nop 3
    s_cmp_ge_u32 s99, 4
    s_cbranch_scc1 proj_vm9
    s_load_dwordx2 s[42:43], s[0:1], 80
    s_waitcnt lgkmcnt(0)
    s_mov_b32 s28, s42
    s_and_b32 s29, s43, 0xffff
    s_mov_b32 s30, 256
    s_mov_b32 s31, 0x20000
    v_mov_b32 v191, 0
    s_mov_b32 s98, 0
proj_mk10:
    buffer_load_dword v190, v191, s[28:31], 0 offen sc1
    s_waitcnt vmcnt(0)
    v_readfirstlane_b32 s99, v190
    s_nop 3
    s_cmp_ge_u32 s99, 4
    s_cbranch_scc1 proj_mk10_ok
    s_add_u32 s98, s98, 1
    s_cmp_lt_u32 s98, 0x40000
    s_cbranch_scc0 proj_mk10_ok
    s_sleep 2
    s_branch proj_mk10
proj_mk10_ok:
proj_vm9:
    v_mov_b32 v190, 163832
proj_bsp:
    ds_read_b32 v191, v190
    s_waitcnt lgkmcnt(0)
    v_readfirstlane_b32 s99, v191
    s_nop 3
    s_cmp_ge_u32 s99, 4
    s_cbranch_scc1 proj_bsp_ok
    s_sleep 1
    s_branch proj_bsp
proj_bsp_ok:
    v_mov_b32 v192, 1
    v_mov_b32 v190, 2146435072
    v_mov_b32 v191, 0
    v_cmp_eq_u32 vcc, 0, v0
    s_mov_b32 s99, 7230464
    s_nop 0
    v_cndmask_b32 v190, v190, v191, vcc
    buffer_atomic_add v192, v190, s[32:35], s99 offen sc0 sc1
    s_waitcnt vmcnt(0)
    v_readfirstlane_b32 s99, v192
    s_nop 3
    s_cmp_eq_u32 s99, 63
    s_cbranch_scc0 proj_ic11
    v_lshlrev_b32 v190, 7, v0
    v_mov_b32 v191, 2146435072
    v_cmp_gt_u32 vcc, 32, v0
    v_mov_b32 v189, 1
    s_mov_b32 s99, 7254016
    v_cndmask_b32 v190, v191, v190, vcc
    buffer_store_dword v189, v190, s[32:35], s99 offen sc1
proj_ic11:
proj_nobs:
    s_cmp_eq_u32 s50, 0
    s_cbranch_scc1 proj_qout
    v_mov_b32 v8, 0x3f803f80
    v_mov_b32 v9, v8
    v_mov_b32 v10, v8
    v_mov_b32 v11, v8
    v_lshlrev_b32 v178, 4, v0
    v_and_b32 v178, 255, v178
    v_add_u32 v178, 39168, v178
    ds_write_b128 v178, v[8:11]
    s_branch proj_kvout
proj_fin:
    s_waitcnt vmcnt(0)
    s_barrier
    s_cmp_eq_u32 s14, 4
    s_cbranch_scc0 proj_z1x
    s_waitcnt vmcnt(0)
    v_readfirstlane_b32 s99, v194
    s_nop 3
    s_cmp_ge_u32 s99, 4
    s_cbranch_scc1 proj_vm12
    s_load_dwordx2 s[42:43], s[0:1], 80
    s_waitcnt lgkmcnt(0)
    s_mov_b32 s28, s42
    s_and_b32 s29, s43, 0xffff
    s_mov_b32 s30, 256
    s_mov_b32 s31, 0x20000
    v_mov_b32 v191, 0
    s_mov_b32 s98, 0
proj_mk13:
    buffer_load_dword v190, v191, s[28:31], 0 offen sc1
    s_waitcnt vmcnt(0)
    v_readfirstlane_b32 s99, v190
    s_nop 3
    s_cmp_ge_u32 s99, 4
    s_cbranch_scc1 proj_mk13_ok
    s_add_u32 s98, s98, 1
    s_cmp_lt_u32 s98, 0x40000
    s_cbranch_scc0 proj_mk13_ok
    s_sleep 2
    s_branch proj_mk13
proj_mk13_ok:
proj_vm12:
    s_lshr_b32 s42, s13, 2
    s_lshl_b32 s42, s42, 4
    s_add_u32 s42, s42, s12
    s_lshl_b32 s42, s42, 2
    s_and_b32 s43, s13, 3
    s_add_u32 s42, s42, s43
    s_lshl_b32 s42, s42, 7
    s_add_u32 s42, s42, 23552
    v_mov_b32 v189, 1
    v_mov_b32 v190, 2146435072
    v_mov_b32 v191, 0
    v_cmp_eq_u32 vcc, 0, v0
    s_add_u32 s99, s42, 7208960
    s_nop 0
    v_cndmask_b32 v190, v190, v191, vcc
    buffer_store_dword v189, v190, s[32:35], s99 offen sc1
    s_cmp_eq_u32 s13, 2
    s_cbranch_scc0 proj_z1a
    s_lshl_b32 s42, s12, 7
    s_add_u32 s42, s42, 39936
    v_mov_b32 v189, 1
    v_mov_b32 v190, 2146435072
    v_mov_b32 v191, 0
    v_cmp_eq_u32 vcc, 0, v0
    s_add_u32 s99, s42, 7208960
    s_nop 0
    v_cndmask_b32 v190, v190, v191, vcc
    buffer_store_dword v189, v190, s[32:35], s99 offen sc1
proj_z1a:
proj_z1x:
proj_p2:
    s_mov_b32 s4, s56
    s_mov_b32 s5, s57
    s_mov_b32 s6, s96
    s_mov_b32 s7, s97
    s_and_b32 s26, s2, 7
    s_lshr_b32 s27, s2, 3
    s_and_b32 s19, s27, 3
    s_lshl_b32 s28, s19, 3
    s_add_u32 s13, s26, s28
    s_lshr_b32 s12, s2, 5
    s_add_u32 s19, s19, s12
    s_and_b32 s19, s19, 3
    v_lshlrev_b32 v4, 4, v0
    v_lshrrev_b32 v1, 5, v0
    v_and_b32 v2, 31, v0
    s_and_b32 s15, s14, 3
    s_lshr_b32 s16, s14, 2
    s_xor_b32 s16, s16, 1
    s_setprio 1
    s_lshl_b32 s36, s12, 2
    s_add_u32 s36, s36, s15
    v_lshlrev_b32 v5, 2, v2
    v_cmp_eq_u32 vcc, 0, v1
    v_mov_b32 v176, 2146435072
    s_nop 0
    v_cndmask_b32 v5, v176, v5, vcc
    s_mov_b32 s8, s4
    s_and_b32 s9, s5, 0xffff
    s_mov_b32 s10, 16777216
    s_mov_b32 s11, 0x20000
    s_add_u32 s20, s4, 4718592
    s_addc_u32 s21, s5, 0
    s_and_b32 s21, s21, 0xffff
    s_mov_b32 s22, 155648
    s_mov_b32 s23, 0x20000
    s_add_u32 s26, s19, 0
    s_and_b32 s26, s26, 3
    s_mul_i32 s26, s26, 38912
    s_sub_u32 s48, s26, 0
    s_add_u32 s26, s19, 1
    s_and_b32 s26, s26, 3
    s_mul_i32 s26, s26, 38912
    s_sub_u32 s49, s26, 38912
    s_add_u32 s26, s19, 2
    s_and_b32 s26, s26, 3
    s_mul_i32 s26, s26, 38912
    s_sub_u32 s50, s26, 77824
    s_add_u32 s26, s19, 3
    s_and_b32 s26, s26, 3
    s_mul_i32 s26, s26, 38912
    s_sub_u32 s51, s26, 116736
    s_cmp_eq_u32 s14, 4
    s_cbranch_scc0 attn_kernel_nox
    s_getreg_b32 s28, hwreg(HW_REG_XCC_ID, 0, 3)
    s_lshl_b32 s28, s28, 2
    s_lshl_b32 s28, 1, s28
    v_mov_b32 v186, s28
    v_mov_b32 v187, 2146435072
    v_mov_b32 v188, 0
    v_cmp_eq_u32 vcc, 0, v0
    s_nop 1
    v_cndmask_b32 v187, v187, v188, vcc
    s_lshl_b32 s28, s13, 7
    s_add_u32 s28, s28, 7218176
    buffer_atomic_add v186, v187, s[8:11], s28 offen sc1
attn_kernel_nox:
    s_lshr_b32 s26, s13, 1
    s_lshl_b32 s26, s26, 2
    s_lshr_b32 s30, s12, 1
    s_add_u32 s26, s26, s30
    s_lshl_b32 s26, s26, 7
    s_add_u32 s26, s26, 23552
    s_and_b32 s30, s2, 31
    s_lshl_b32 s30, s30, 7
    s_add_u32 s30, s30, 45056
    v_mov_b32 v194, s30
    v_mov_b32 v195, 1
    v_mov_b32 v196, s26
    v_mov_b32 v198, 1
    v_cmp_eq_u32 vcc, 1, v0
    s_nop 1
    v_cndmask_b32 v194, v194, v196, vcc
    v_cndmask_b32 v195, v195, v198, vcc
    s_mov_b32 s25, 0
    s_mov_b32 s24, 7208960
attn_kernel_pm1:
    buffer_load_dword v197, v194, s[8:11], s24 offen sc1
    s_waitcnt vmcnt(0)
    v_cmp_lt_u32 vcc, v197, v195
    s_nop 3
    s_and_b32 s26, vcc_lo, 3
    s_cbranch_scc0 attn_kernel_pm1_ok
    s_add_u32 s25, s25, 1
    s_cmp_lt_u32 s25, 0x40000
    s_cbranch_scc0 attn_kernel_pm1_ok
    s_sleep 4
    s_branch attn_kernel_pm1
attn_kernel_pm1_ok:
    s_lshl_b32 s27, s36, 6
    s_lshl_b32 s28, s13, 1
    s_add_u32 s27, s27, s28
    s_lshl_b32 s28, s27, 10
    s_lshl_b32 s29, s27, 7
    s_add_u32 s29, s29, 4194304
    buffer_load_dwordx4 v[8:11], v4, s[8:11], s28 offen
    buffer_load_dwordx4 v[14:17], v4, s[8:11], s28 offen offset:1024
    buffer_load_dword v12, v5, s[8:11], s29 offen
    buffer_load_dword v18, v5, s[8:11], s29 offen offset:128
    s_mov_b32 s25, 7230592
    v_and_b32 v177, 1, v0
    v_lshlrev_b32 v177, 7, v177
    buffer_load_dword v178, v177, s[8:11], s25 offen sc1
    s_cmp_eq_u32 s16, 0
    s_cbranch_scc1 attn_kernel_adma
    s_mov_b32 s17, 77824
    s_add_u32 m0, s17, 0
    s_add_u32 s26, m0, s50
    buffer_load_dwordx4 v4, s[20:23], s26 offen lds
    s_add_u32 m0, s17, 1024
    s_add_u32 s26, m0, s50
    buffer_load_dwordx4 v4, s[20:23], s26 offen lds
    s_add_u32 m0, s17, 2048
    s_add_u32 s26, m0, s50
    buffer_load_dwordx4 v4, s[20:23], s26 offen lds
    s_add_u32 m0, s17, 3072
    s_add_u32 s26, m0, s50
    buffer_load_dwordx4 v4, s[20:23], s26 offen lds
    s_add_u32 m0, s17, 4096
    s_add_u32 s26, m0, s50
    buffer_load_dwordx4 v4, s[20:23], s26 offen lds
    s_add_u32 m0, s17, 5120
    s_add_u32 s26, m0, s50
    buffer_load_dwordx4 v4, s[20:23], s26 offen lds
    s_add_u32 m0, s17, 6144
    s_add_u32 s26, m0, s50
    buffer_load_dwordx4 v4, s[20:23], s26 offen lds
    s_add_u32 m0, s17, 7168
    s_add_u32 s26, m0, s50
    buffer_load_dwordx4 v4, s[20:23], s26 offen lds
    s_add_u32 m0, s17, 8192
    s_add_u32 s26, m0, s50
    buffer_load_dwordx4 v4, s[20:23], s26 offen lds
    s_add_u32 m0, s17, 9216
    s_add_u32 s26, m0, s50
    buffer_load_dwordx4 v4, s[20:23], s26 offen lds
    s_add_u32 m0, s17, 10240
    s_add_u32 s26, m0, s50
    buffer_load_dwordx4 v4, s[20:23], s26 offen lds
    s_add_u32 m0, s17, 11264
    s_add_u32 s26, m0, s50
    buffer_load_dwordx4 v4, s[20:23], s26 offen lds
    s_branch attn_kernel_dmadone
attn_kernel_adma:
    v_mov_b32 v180, 163828
    v_mov_b32 v181, 1
    s_mov_b32 exec_hi, 0
    s_mov_b32 exec_lo, 1
    ds_add_u32 v180, v181
    s_mov_b64 exec, -1
    s_lshl_b32 s27, s15, 10
    s_add_u32 m0, s27, 89088
    s_add_u32 s26, m0, s50
    buffer_load_dwordx4 v4, s[20:23], s26 offen lds
    s_add_u32 m0, s27, 93184
    s_add_u32 s26, m0, s50
    buffer_load_dwordx4 v4, s[20:23], s26 offen lds
    s_add_u32 m0, s27, 97280
    s_add_u32 s26, m0, s50
    buffer_load_dwordx4 v4, s[20:23], s26 offen lds
    s_add_u32 m0, s27, 101376
    s_add_u32 s26, m0, s50
    buffer_load_dwordx4 v4, s[20:23], s26 offen lds
    s_add_u32 m0, s27, 105472
    s_add_u32 s26, m0, s50
    buffer_load_dwordx4 v4, s[20:23], s26 offen lds
    s_add_u32 m0, s27, 109568
    s_add_u32 s26, m0, s50
    buffer_load_dwordx4 v4, s[20:23], s26 offen lds
    s_add_u32 s28, s15, 24
    s_min_u32 s28, s28, 26
    s_lshl_b32 s28, s28, 10
    s_add_u32 m0, s28, 89088
    s_add_u32 s26, m0, s50
    buffer_load_dwordx4 v4, s[20:23], s26 offen lds
attn_kernel_dmadone:
    s_mul_i32 s28, s16, 77824
    v_add_u32 v144, s28, v4
    v_lshlrev_b32 v145, 2, v2
    v_add_u32 v145, s28, v145
    v_add_u32 v145, 1024, v145
    v_lshlrev_b32 v180, 8, v1
    v_lshlrev_b32 v181, 4, v2
    v_add_u32 v180, v180, v181
    v_add_u32 v180, 1152, v180
    v_lshlrev_b32 v182, 6, v1
    v_add_u32 v182, v182, v181
    v_add_u32 v182, 1920, v182
    v_cmp_gt_u32 vcc, 16, v2
    v_add_u32 v183, 512, v180
    v_add_u32 v184, 128, v182
    v_cndmask_b32 v180, v182, v180, vcc
    v_cndmask_b32 v183, v184, v183, vcc
    v_add_u32 v180, s28, v180
    v_add_u32 v183, s28, v183
    v_cmp_gt_u32 vcc, 19, v2
    v_mov_b32 v181, 0x80000
    s_nop 0
    v_cndmask_b32 v146, v181, v180, vcc
    v_cndmask_b32 v174, v181, v183, vcc
    v_mov_b32 v147, 0xdddddddd
    v_mov_b32 v121, 0x3f80
    v_mov_b32 v135, 0x3f80
    v_mov_b32 v140, 0
    v_mov_b32 v141, 0
    v_mov_b32 v142, 0
    v_mov_b32 v143, 0
    v_mov_b32 v108, 0
    v_mov_b32 v109, 0
    v_mov_b32 v110, 0
    v_mov_b32 v111, 0
    v_mov_b32 v112, 0
    v_mov_b32 v113, 0
    v_mov_b32 v114, 0
    v_mov_b32 v115, 0
    v_mov_b32 v20, 0
    v_mov_b32 v21, 0
    v_mov_b32 v22, 0
    v_mov_b32 v23, 0
    v_mov_b32 v24, 0
    v_mov_b32 v25, 0
    v_mov_b32 v26, 0
    v_mov_b32 v27, 0
    v_mov_b32 v28, 0
    v_mov_b32 v29, 0
    v_mov_b32 v30, 0
    v_mov_b32 v31, 0
    v_mov_b32 v32, 0
    v_mov_b32 v33, 0
    v_mov_b32 v34, 0
    v_mov_b32 v35, 0
    v_mov_b32 v36, 0
    v_mov_b32 v37, 0
    v_mov_b32 v38, 0
    v_mov_b32 v39, 0
    v_mov_b32 v40, 0
    v_mov_b32 v41, 0
    v_mov_b32 v42, 0
    v_mov_b32 v43, 0
    v_mov_b32 v44, 0
    v_mov_b32 v45, 0
    v_mov_b32 v46, 0
    v_mov_b32 v47, 0
    v_mov_b32 v48, 0
    v_mov_b32 v49, 0
    v_mov_b32 v50, 0
    v_mov_b32 v51, 0
    v_lshlrev_b32 v185, 4, v2
    s_lshl_b32 s28, s12, 3
    s_lshl_b32 s29, s15, 1
    s_add_u32 s28, s28, s29
    s_lshl_b32 s28, s28, 9
    v_lshlrev_b32 v186, 9, v1
    v_add_u32 v186, v186, v185
    v_add_u32 v200, s28, v186
    s_add_u32 s28, s12, 64
    s_lshl_b32 s28, s28, 9
    s_lshl_b32 s29, s15, 2
    s_add_u32 s28, s28, s29
    v_add_u32 v185, s28, v185
    v_mov_b32 v186, 2146435072
    v_cmp_eq_u32 vcc, 0, v1
    s_nop 1
    v_cndmask_b32 v201, v186, v185, vcc
    s_lshl_b32 s29, s13, 1
    s_add_u32 s29, s29, s16
    s_mul_i32 s29, s29, 36864
    s_add_u32 s37, s29, 7340032
    v_and_b32 v175, 7, v2
    v_lshlrev_b32 v185, 3, v1
    v_add_u32 v175, v175, v185
    v_lshlrev_b32 v175, 4, v175
    v_add_u32 v175, 2048, v175
    s_lshl_b32 s28, s14, 8
    v_lshlrev_b32 v206, 2, v0
    v_add_u32 v207, 160768, v206
    v_add_u32 v206, s28, v207
    s_xor_b32 s28, s14, 4
    s_lshl_b32 s28, s28, 8
    v_add_u32 v207, s28, v207
    s_mov_b32 s55, 0
    v_mov_b32 v173, 0
    ds_write_b32 v206, v173
    s_cmp_eq_u32 s16, 0
    s_cbranch_scc1 attn_kernel_w7
    s_waitcnt vmcnt(12)
    s_branch attn_kernel_w12
attn_kernel_w7:
    s_waitcnt vmcnt(7)
    s_cmp_eq_u32 s100, 0
    s_cbranch_scc1 attn_kernel_w12
    s_add_u32 s28, s100, 7208960
    v_mov_b32 v186, 1
    v_mov_b32 v187, 2146435072
    v_mov_b32 v188, 0
    v_cmp_eq_u32 vcc, 0, v0
    s_nop 1
    v_cndmask_b32 v187, v187, v188, vcc
    buffer_atomic_add v186, v187, s[8:11], s28 offen sc1
attn_kernel_w12:
    v_readlane_b32 s28, v178, 0
    v_readlane_b32 s29, v178, 1
    v_mov_b32 v180, 0
    v_mov_b32 v181, 0
    v_mov_b32 v178, s28
    v_dot2_f32_bf16 v180, v8, v8, v180
    v_dot2_f32_bf16 v181, v14, v14, v181
    v_dot2_f32_bf16 v180, v9, v9, v180
    v_dot2_f32_bf16 v181, v15, v15, v181
    v_dot2_f32_bf16 v180, v10, v10, v180
    v_dot2_f32_bf16 v181, v16, v16, v181
    v_dot2_f32_bf16 v180, v11, v11, v180
    v_dot2_f32_bf16 v181, v17, v17, v181
    v_dot2_f32_bf16 v180, v12, v12, v180
    v_dot2_f32_bf16 v181, v18, v18, v181
    v_add_f32 v178, s29, v178
    v_mov_b32 v184, 0x3f820000
    v_mov_b32 v185, 0x42200000
    v_mov_b32 v182, v180
    v_mov_b32 v183, v181
    s_nop 1
    v_permlane32_swap_b32 v180, v182
    v_permlane32_swap_b32 v181, v183
    v_cmp_eq_u32 vcc, 0, v1
    v_add_f32 v180, v180, v182
    v_add_f32 v181, v181, v183
    v_mul_f32 v180, v180, v178
    v_mul_f32 v181, v181, v178
    v_sqrt_f32 v180, v180
    v_sqrt_f32 v181, v181
    s_nop 0
    v_fma_f32 v180, -v180, v184, v185
    v_fma_f32 v181, -v181, v184, v185
    v_cvt_pk_bf16_f32 v182, v180, 0
    v_cvt_pk_bf16_f32 v183, v181, 0
    v_lshlrev_b32 v148, 16, v182
    v_cndmask_b32 v13, 0, v182, vcc
    v_lshlrev_b32 v149, 16, v183
    v_cndmask_b32 v19, 0, v183, vcc
    s_cmp_eq_u32 s16, 0
    s_cbranch_scc0 attn_kernel_lstart
    v_mov_b32 v180, 163828
attn_kernel_cz2:
    ds_read_b32 v181, v180
    s_waitcnt lgkmcnt(0)
    v_readfirstlane_b32 s29, v181
    s_nop 3
    s_cmp_ge_u32 s29, 4
    s_cbranch_scc1 attn_kernel_cz2_ok
    s_sleep 1
    s_branch attn_kernel_cz2
attn_kernel_cz2_ok:
    s_lshl_b32 s27, s15, 10
    s_add_u32 m0, s27, 0
    s_add_u32 s26, m0, s48
    buffer_load_dwordx4 v4, s[20:23], s26 offen lds
    s_add_u32 m0, s27, 4096
    s_add_u32 s26, m0, s48
    buffer_load_dwordx4 v4, s[20:23], s26 offen lds
    s_add_u32 m0, s27, 8192
    s_add_u32 s26, m0, s48
    buffer_load_dwordx4 v4, s[20:23], s26 offen lds
    s_add_u32 m0, s27, 12288
    s_add_u32 s26, m0, s48
    buffer_load_dwordx4 v4, s[20:23], s26 offen lds
    s_add_u32 m0, s27, 16384
    s_add_u32 s26, m0, s48
    buffer_load_dwordx4 v4, s[20:23], s26 offen lds
    s_add_u32 m0, s27, 20480
    s_add_u32 s26, m0, s48
    buffer_load_dwordx4 v4, s[20:23], s26 offen lds
    s_add_u32 m0, s27, 24576
    s_add_u32 s26, m0, s48
    buffer_load_dwordx4 v4, s[20:23], s26 offen lds
    s_add_u32 m0, s27, 28672
    s_add_u32 s26, m0, s48
    buffer_load_dwordx4 v4, s[20:23], s26 offen lds
    s_add_u32 m0, s27, 32768
    s_add_u32 s26, m0, s48
    buffer_load_dwordx4 v4, s[20:23], s26 offen lds
    s_min_u32 s28, s15, 1
    s_lshl_b32 s28, s28, 10
    s_add_u32 m0, s28, 36864
    s_add_u32 s26, m0, s48
    buffer_load_dwordx4 v4, s[20:23], s26 offen lds
    s_add_u32 m0, s27, 38912
    s_add_u32 s26, m0, s49
    buffer_load_dwordx4 v4, s[20:23], s26 offen lds
    s_add_u32 m0, s27, 43008
    s_add_u32 s26, m0, s49
    buffer_load_dwordx4 v4, s[20:23], s26 offen lds
    s_add_u32 m0, s27, 47104
    s_add_u32 s26, m0, s49
    buffer_load_dwordx4 v4, s[20:23], s26 offen lds
    s_add_u32 m0, s27, 51200
    s_add_u32 s26, m0, s49
    buffer_load_dwordx4 v4, s[20:23], s26 offen lds
    s_add_u32 m0, s27, 55296
    s_add_u32 s26, m0, s49
    buffer_load_dwordx4 v4, s[20:23], s26 offen lds
    s_add_u32 m0, s27, 59392
    s_add_u32 s26, m0, s49
    buffer_load_dwordx4 v4, s[20:23], s26 offen lds
    s_add_u32 m0, s27, 63488
    s_add_u32 s26, m0, s49
    buffer_load_dwordx4 v4, s[20:23], s26 offen lds
    s_add_u32 m0, s27, 67584
    s_add_u32 s26, m0, s49
    buffer_load_dwordx4 v4, s[20:23], s26 offen lds
    s_add_u32 m0, s27, 71680
    s_add_u32 s26, m0, s49
    buffer_load_dwordx4 v4, s[20:23], s26 offen lds
    s_add_u32 s28, s27, 75776
    s_add_u32 s25, s27, 114688
    s_cmp_lt_u32 s15, 2
    s_cselect_b32 s29, s49, s51
    s_cselect_b32 m0, s28, s25
    s_add_u32 s26, m0, s29
    buffer_load_dwordx4 v4, s[20:23], s26 offen lds
    s_add_u32 m0, s27, 118784
    s_add_u32 s26, m0, s51
    buffer_load_dwordx4 v4, s[20:23], s26 offen lds
    s_add_u32 m0, s27, 122880
    s_add_u32 s26, m0, s51
    buffer_load_dwordx4 v4, s[20:23], s26 offen lds
    s_add_u32 m0, s27, 126976
    s_add_u32 s26, m0, s51
    buffer_load_dwordx4 v4, s[20:23], s26 offen lds
    s_add_u32 m0, s27, 131072
    s_add_u32 s26, m0, s51
    buffer_load_dwordx4 v4, s[20:23], s26 offen lds
    s_add_u32 m0, s27, 135168
    s_add_u32 s26, m0, s51
    buffer_load_dwordx4 v4, s[20:23], s26 offen lds
    s_add_u32 m0, s27, 139264
    s_add_u32 s26, m0, s51
    buffer_load_dwordx4 v4, s[20:23], s26 offen lds
    s_add_u32 m0, s27, 143360
    s_add_u32 s26, m0, s51
    buffer_load_dwordx4 v4, s[20:23], s26 offen lds
    s_add_u32 m0, s27, 147456
    s_add_u32 s26, m0, s51
    buffer_load_dwordx4 v4, s[20:23], s26 offen lds
    s_add_u32 m0, s27, 151552
    s_add_u32 s26, m0, s51
    buffer_load_dwordx4 v4, s[20:23], s26 offen lds
    s_waitcnt vmcnt(19)
    s_barrier
    s_mov_b32 s25, 1
    s_mov_b32 s18, 1
    s_mov_b32 s39, 0
    s_branch attn_kernel_pass
attn_kernel_lstart:
    s_waitcnt vmcnt(0)
    s_mov_b32 s25, 2
    s_mov_b32 s30, 6
    s_mov_b32 s31, 1
    s_mov_b32 s18, 0
    s_mov_b32 s39, 0
attn_kernel_pass:
    ds_read_b128 v[116:119], v144
    ds_read_b32 v120, v145
    ds_read_b128 v[122:125], v146
    ds_read_b128 v[126:129], v174
    s_waitcnt lgkmcnt(0)
    v_mfma_f32_32x32x16_bf16 v[52:67], v[116:119], v[8:11], 0
    v_mfma_f32_32x32x8bf16_1k v[52:67], v[120:121], v[12:13], v[52:67]
    s_nop 7
    s_nop 3
.p2align 6
attn_kernel_loop:
    v_mfma_f32_32x32x16_bf16 v[68:83], v[116:119], v[14:17], 0
    v_exp_f32 v52, v52
    ds_read_b128 v[130:133], v144 offset:2432
    v_exp_f32 v53, v53
    ds_read_b32 v134, v145 offset:2432
    v_exp_f32 v54, v54
    ds_read_b128 v[136:139], v146 offset:2432
    v_exp_f32 v55, v55
    v_mfma_f32_32x32x8bf16_1k v[68:83], v[120:121], v[18:19], v[68:83]
    v_exp_f32 v56, v56
    v_exp_f32 v57, v57
    v_exp_f32 v58, v58
    v_exp_f32 v59, v59
    v_smfmac_f32_32x32x32_bf16 v[36:51], v[140:143], v[108:115], v147
    v_exp_f32 v60, v60
    ds_read_b128 v[140:143], v174 offset:2432
    v_exp_f32 v61, v61
    v_exp_f32 v62, v62
    v_exp_f32 v63, v63
    v_smfmac_f32_32x32x32_bf16 v[20:35], v[122:125], v[52:59], v147
    v_exp_f32 v64, v64
    v_exp_f32 v65, v65
    v_exp_f32 v66, v66
    v_exp_f32 v67, v67
    s_waitcnt lgkmcnt(1)
    v_mfma_f32_32x32x16_bf16 v[84:99], v[130:133], v[8:11], 0
    v_exp_f32 v68, v68
    v_exp_f32 v69, v69
    v_exp_f32 v70, v70
    v_exp_f32 v71, v71
    v_mfma_f32_32x32x8bf16_1k v[84:99], v[134:135], v[12:13], v[84:99]
    v_exp_f32 v72, v72
    v_exp_f32 v73, v73
    v_exp_f32 v74, v74
    v_exp_f32 v75, v75
    v_smfmac_f32_32x32x32_bf16 v[20:35], v[126:129], v[60:67], v147
    v_exp_f32 v76, v76
    v_exp_f32 v77, v77
    v_exp_f32 v78, v78
    v_exp_f32 v79, v79
    v_smfmac_f32_32x32x32_bf16 v[36:51], v[122:125], v[68:75], v147
    v_exp_f32 v80, v80
    v_exp_f32 v81, v81
    v_exp_f32 v82, v82
    v_exp_f32 v83, v83
    v_mfma_f32_32x32x16_bf16 v[100:115], v[130:133], v[14:17], 0
    v_exp_f32 v84, v84
    ds_read_b128 v[116:119], v144 offset:4864
    v_exp_f32 v85, v85
    ds_read_b32 v120, v145 offset:4864
    v_exp_f32 v86, v86
    ds_read_b128 v[122:125], v146 offset:4864
    v_exp_f32 v87, v87
    v_mfma_f32_32x32x8bf16_1k v[100:115], v[134:135], v[18:19], v[100:115]
    v_exp_f32 v88, v88
    v_exp_f32 v89, v89
    v_exp_f32 v90, v90
    v_exp_f32 v91, v91
    v_smfmac_f32_32x32x32_bf16 v[36:51], v[126:129], v[76:83], v147
    v_exp_f32 v92, v92
    ds_read_b128 v[126:129], v174 offset:4864
    v_exp_f32 v93, v93
    v_exp_f32 v94, v94
    v_exp_f32 v95, v95
    v_smfmac_f32_32x32x32_bf16 v[20:35], v[136:139], v[84:91], v147
    v_exp_f32 v96, v96
    v_exp_f32 v97, v97
    v_exp_f32 v98, v98
    v_exp_f32 v99, v99
    s_waitcnt lgkmcnt(1)
    v_mfma_f32_32x32x16_bf16 v[52:67], v[116:119], v[8:11], 0
    v_exp_f32 v100, v100
    v_exp_f32 v101, v101
    v_exp_f32 v102, v102
    v_exp_f32 v103, v103
    v_mfma_f32_32x32x8bf16_1k v[52:67], v[120:121], v[12:13], v[52:67]
    v_exp_f32 v104, v104
    v_exp_f32 v105, v105
    v_exp_f32 v106, v106
    v_exp_f32 v107, v107
    v_smfmac_f32_32x32x32_bf16 v[20:35], v[140:143], v[92:99], v147
    v_exp_f32 v108, v108
    v_exp_f32 v109, v109
    v_exp_f32 v110, v110
    v_exp_f32 v111, v111
    v_smfmac_f32_32x32x32_bf16 v[36:51], v[136:139], v[100:107], v147
    v_exp_f32 v112, v112
    v_exp_f32 v113, v113
    v_exp_f32 v114, v114
    v_exp_f32 v115, v115
    v_add_u32 v144, 4864, v144
    v_add_u32 v145, 4864, v145
    v_add_u32 v146, 4864, v146
    v_add_u32 v174, 4864, v174
    s_sub_u32 s25, s25, 1
    s_cmp_lg_u32 s25, 0
    s_cbranch_scc1 attn_kernel_loop
    s_add_u32 s18, s18, 1
    s_cmp_eq_u32 s18, 2
    s_cbranch_scc1 attn_kernel_hook1
    s_cmp_eq_u32 s18, 3
    s_cbranch_scc1 attn_kernel_hook2
    s_cmp_eq_u32 s18, 4
    s_cbranch_scc1 attn_kernel_hook4
    s_cmp_eq_u32 s18, 1
    s_cbranch_scc0 attn_kernel_loopdone
    s_barrier
    s_mov_b32 s25, 4
    s_branch attn_kernel_loop
attn_kernel_hook1:
    s_waitcnt vmcnt(0)
    s_barrier
    s_cmp_eq_u32 s16, 0
    s_cbranch_scc0 attn_kernel_h1l
    s_cmp_eq_u32 s101, 0
    s_cbranch_scc1 attn_kernel_nows
    s_add_u32 s28, s101, 7208960
    v_mov_b32 v186, 1
    v_mov_b32 v187, 2146435072
    v_mov_b32 v188, 0
    v_cmp_eq_u32 vcc, 0, v0
    s_nop 1
    v_cndmask_b32 v187, v187, v188, vcc
    buffer_atomic_add v186, v187, s[8:11], s28 offen sc1
attn_kernel_nows:
    s_mov_b32 s25, 1
    s_branch attn_kernel_loop
attn_kernel_h1l:
    s_lshr_b32 s26, s13, 1
    s_lshl_b32 s26, s26, 7
    s_add_u32 s26, s26, 39936
    v_mov_b32 v194, s26
    v_mov_b32 v195, 1
    s_mov_b32 s25, 0
    s_mov_b32 s24, 7208960
attn_kernel_pm3:
    buffer_load_dword v197, v194, s[8:11], s24 offen sc1
    s_waitcnt vmcnt(0)
    v_cmp_lt_u32 vcc, v197, v195
    s_nop 3
    s_and_b32 s26, vcc_lo, 1
    s_cbranch_scc0 attn_kernel_pm3_ok
    s_add_u32 s25, s25, 1
    s_cmp_lt_u32 s25, 0x40000
    s_cbranch_scc0 attn_kernel_pm3_ok
    s_sleep 4
    s_branch attn_kernel_pm3
attn_kernel_pm3_ok:
    s_lshl_b32 s28, s13, 7
    s_add_u32 s28, s28, 7218176
    v_mov_b32 v196, 0
    s_mov_b32 s25, 0
attn_kernel_xp4:
    buffer_load_dword v197, v196, s[8:11], s28 offen sc1
    s_waitcnt vmcnt(0)
    v_readfirstlane_b32 s29, v197
    s_nop 3
    s_and_b32 s26, s29, 0x0f0f0f0f
    s_lshr_b32 s27, s29, 4
    s_and_b32 s27, s27, 0x0f0f0f0f
    s_add_u32 s26, s26, s27
    s_mul_i32 s26, s26, 0x01010101
    s_lshr_b32 s26, s26, 24
    s_cmp_ge_u32 s26, 8
    s_cbranch_scc1 attn_kernel_xp4_ok
    s_add_u32 s25, s25, 1
    s_cmp_lt_u32 s25, 0x40000
    s_cbranch_scc0 attn_kernel_xp4_ok
    s_sleep 2
    s_branch attn_kernel_xp4
attn_kernel_xp4_ok:
    v_readlane_b32 s29, v197, 0
    s_nop 3
    s_getreg_b32 s26, hwreg(HW_REG_XCC_ID, 0, 3)
    s_lshl_b32 s26, s26, 2
    s_lshl_b32 s26, 8, s26
    s_cmp_eq_u32 s26, s29
    s_cselect_b32 s52, 1, 0
    s_lshl_b32 s28, s13, 1
    s_add_u32 s28, s28, s16
    s_lshl_b32 s28, s28, 7
    s_add_u32 s28, s28, 4915200
    v_lshlrev_b32 v180, 2, v2
    buffer_load_dword v155, v180, s[8:11], s28 offen
    s_mov_b32 s25, s30
    s_branch attn_kernel_loop
attn_kernel_hook2:
    s_cmp_eq_u32 s16, 0
    s_cbranch_scc1 attn_kernel_hookB
    s_setprio 0
    v_lshlrev_b32 v194, 7, v0
    v_add_u32 v194, 43008, v194
    v_mov_b32 v195, 36
    v_cmp_gt_u32 vcc, 16, v0
    v_mov_b32 v196, 43008
    s_nop 0
    v_cndmask_b32 v194, v196, v194, vcc
    s_mov_b32 s25, 0
    s_mov_b32 s24, 7208960
attn_kernel_pm5:
    buffer_load_dword v197, v194, s[8:11], s24 offen sc1
    s_waitcnt vmcnt(0)
    v_cmp_lt_u32 vcc, v197, v195
    s_nop 3
    s_and_b32 s26, vcc_lo, 65535
    s_cbranch_scc0 attn_kernel_pm5_ok
    s_add_u32 s25, s25, 1
    s_cmp_lt_u32 s25, 0x40000
    s_cbranch_scc0 attn_kernel_pm5_ok
    s_sleep 4
    s_branch attn_kernel_pm5
attn_kernel_pm5_ok:
    s_lshr_b32 s28, s2, 3
    s_mul_i32 s28, s28, 41472
    s_mul_i32 s29, s15, 11264
    s_add_u32 s28, s28, s29
    s_add_u32 s28, s28, 5832704
    buffer_load_dwordx4 v[252:255], v4, s[8:11], s28 offen offset:0
    buffer_load_dwordx4 v[252:255], v4, s[8:11], s28 offen offset:1024
    buffer_load_dwordx4 v[252:255], v4, s[8:11], s28 offen offset:2048
    buffer_load_dwordx4 v[252:255], v4, s[8:11], s28 offen offset:3072
    s_add_u32 s28, s28, 4096
    buffer_load_dwordx4 v[252:255], v4, s[8:11], s28 offen offset:0
    buffer_load_dwordx4 v[252:255], v4, s[8:11], s28 offen offset:1024
    buffer_load_dwordx4 v[252:255], v4, s[8:11], s28 offen offset:2048
    buffer_load_dwordx4 v[252:255], v4, s[8:11], s28 offen offset:3072
    s_add_u32 s28, s28, 4096
    buffer_load_dwordx4 v[252:255], v4, s[8:11], s28 offen offset:0
    buffer_load_dwordx4 v[252:255], v4, s[8:11], s28 offen offset:1024
    buffer_load_dwordx4 v[252:255], v4, s[8:11], s28 offen offset:2048
    s_mov_b32 s25, s31
    s_cmp_lg_u32 s31, 0
    s_cbranch_scc1 attn_kernel_loop
    s_branch attn_kernel_hook4
attn_kernel_hookB:
    s_lshr_b32 s26, s13, 1
    s_add_u32 s27, s26, 16
    s_lshl_b32 s27, s27, 2
    s_lshr_b32 s28, s12, 1
    s_add_u32 s27, s27, s28
    s_lshl_b32 s27, s27, 7
    s_add_u32 s30, s27, 23552
    s_lshl_b32 s26, s26, 7
    s_add_u32 s31, s26, 39936
    s_lshl_b32 s28, s12, 7
    s_add_u32 s28, s28, 41984
    v_mov_b32 v194, s28
    v_mov_b32 v195, 64
    v_mov_b32 v196, s30
    v_mov_b32 v198, 1
    v_cmp_eq_u32 vcc, 1, v0
    s_nop 1
    v_cndmask_b32 v194, v194, v196, vcc
    v_cndmask_b32 v195, v195, v198, vcc
    v_mov_b32 v196, s31
    v_mov_b32 v198, 1
    v_cmp_eq_u32 vcc, 2, v0
    s_nop 1
    v_cndmask_b32 v194, v194, v196, vcc
    v_cndmask_b32 v195, v195, v198, vcc
    s_mov_b32 s25, 0
    s_mov_b32 s24, 7208960
attn_kernel_pm6:
    buffer_load_dword v197, v194, s[8:11], s24 offen sc1
    s_waitcnt vmcnt(0)
    v_cmp_lt_u32 vcc, v197, v195
    s_nop 3
    s_and_b32 s26, vcc_lo, 7
    s_cbranch_scc0 attn_kernel_pm6_ok
    s_add_u32 s25, s25, 1
    s_cmp_lt_u32 s25, 0x40000
    s_cbranch_scc0 attn_kernel_pm6_ok
    s_sleep 4
    s_branch attn_kernel_pm6
attn_kernel_pm6_ok:
    s_lshl_b32 s28, s13, 7
    s_add_u32 s28, s28, 7218176
    v_mov_b32 v196, 0
    s_mov_b32 s25, 0
attn_kernel_xp7:
    buffer_load_dword v197, v196, s[8:11], s28 offen sc1
    s_waitcnt vmcnt(0)
    v_readfirstlane_b32 s29, v197
    s_nop 3
    s_and_b32 s26, s29, 0x0f0f0f0f
    s_lshr_b32 s27, s29, 4
    s_and_b32 s27, s27, 0x0f0f0f0f
    s_add_u32 s26, s26, s27
    s_mul_i32 s26, s26, 0x01010101
    s_lshr_b32 s26, s26, 24
    s_cmp_ge_u32 s26, 8
    s_cbranch_scc1 attn_kernel_xp7_ok
    s_add_u32 s25, s25, 1
    s_cmp_lt_u32 s25, 0x40000
    s_cbranch_scc0 attn_kernel_xp7_ok
    s_sleep 2
    s_branch attn_kernel_xp7
attn_kernel_xp7_ok:
    v_readlane_b32 s29, v197, 0
    s_nop 3
    s_getreg_b32 s26, hwreg(HW_REG_XCC_ID, 0, 3)
    s_lshl_b32 s26, s26, 2
    s_lshl_b32 s26, 8, s26
    s_cmp_eq_u32 s26, s29
    s_cselect_b32 s52, 1, 0
    s_mul_i32 s28, s36, 2560
    s_add_u32 s28, s28, 4980736
    v_lshlrev_b32 v180, 2, v0
    buffer_load_dword v156, v180, s[8:11], s28 offen offset:0 sc1
    buffer_load_dword v157, v180, s[8:11], s28 offen offset:256 sc1
    buffer_load_dword v158, v180, s[8:11], s28 offen offset:512 sc1
    buffer_load_dword v159, v180, s[8:11], s28 offen offset:768 sc1
    buffer_load_dword v160, v180, s[8:11], s28 offen offset:1024 sc1
    buffer_load_dword v161, v180, s[8:11], s28 offen offset:1280 sc1
    buffer_load_dword v162, v180, s[8:11], s28 offen offset:1536 sc1
    buffer_load_dword v163, v180, s[8:11], s28 offen offset:1792 sc1
    buffer_load_dword v164, v180, s[8:11], s28 offen offset:2048 sc1
    buffer_load_dword v165, v180, s[8:11], s28 offen offset:2304 sc1
    s_lshl_b32 s27, s36, 6
    s_lshl_b32 s28, s13, 1
    s_add_u32 s27, s27, s28
    s_lshl_b32 s29, s27, 10
    s_add_u32 s29, s29, 2097152
    buffer_load_dwordx4 v[208:211], v4, s[8:11], s29 offen
    buffer_load_dwordx4 v[214:217], v4, s[8:11], s29 offen offset:1024
    s_lshl_b32 s29, s27, 7
    s_add_u32 s29, s29, 4456448
    buffer_load_dword v212, v5, s[8:11], s29 offen
    buffer_load_dword v218, v5, s[8:11], s29 offen offset:128
    s_lshl_b32 s28, s28, 7
    s_add_u32 s28, s28, 4915200
    v_lshlrev_b32 v180, 2, v2
    buffer_load_dword v155, v180, s[8:11], s28 offen
    buffer_load_dword v166, v180, s[8:11], s28 offen offset:128
    s_waitcnt vmcnt(0)
    v_cvt_pk_bf16_f32 v234, v156, v157
    v_cvt_pk_bf16_f32 v235, v158, v159
    v_cvt_pk_bf16_f32 v236, v160, v161
    v_cvt_pk_bf16_f32 v237, v162, v163
    v_cvt_pk_bf16_f32 v238, v164, v165
    v_mov_b32 v239, 0
    v_mov_b32 v184, 0x3fb8aa3b
    v_mov_b32 v185, 0x358637bd
    v_mov_b32 v190, 0x3fb8aa3b
    v_mov_b32 v191, 0x358637bd
    v_mov_b32 v213, 0
    v_sub_f32 v189, 1.0, v155
    s_nop 1
    v_mfma_f32_32x32x16_bf16 v[240:255], v[234:237], v[208:211], 0
    v_mfma_f32_32x32x8bf16_1k v[240:255], v[238:239], v[212:213], v[240:255]
    s_lshl_b32 s29, s13, 1
    s_add_u32 s29, s29, 64
    s_mul_i32 s29, s29, 36864
    s_add_u32 s30, s29, 7340032
    s_nop 7
    s_nop 1
    v_mov_b32 v188, v250
    v_mov_b32 v187, v250
    s_nop 1
    v_permlane32_swap_b32 v188, v187
    s_nop 1
    v_add_f32 v188, 0x358637bd, v188
    v_rcp_f32 v188, v188
    s_nop 0
    v_mul_f32 v188, v188, v189
    v_mul_f32 v240, v240, v188
    v_mul_f32 v241, v241, v188
    v_mul_f32 v242, v242, v188
    v_mul_f32 v243, v243, v188
    v_mul_f32 v244, v244, v188
    v_mul_f32 v245, v245, v188
    v_mul_f32 v246, v246, v188
    v_mul_f32 v247, v247, v188
    v_mul_f32 v248, v248, v188
    v_mul_f32 v249, v249, v188
    v_cvt_pk_bf16_f32 v240, v240, v241
    v_cvt_pk_bf16_f32 v241, v242, v243
    v_cvt_pk_bf16_f32 v242, v244, v245
    v_cvt_pk_bf16_f32 v243, v246, v247
    v_cvt_pk_bf16_f32 v244, v248, v249
    s_nop 0
    v_permlane32_swap_b32 v240, v242
    v_permlane32_swap_b32 v241, v243
    s_cmp_eq_u32 s52, 0
    s_cbranch_scc1 attn_kernel_tw8s
    buffer_store_dword v244, v201, s[8:11], s30 offen
    buffer_store_dwordx4 v[240:243], v200, s[8:11], s30 offen
    s_branch attn_kernel_tw8e
attn_kernel_tw8s:
    buffer_store_dword v244, v201, s[8:11], s30 offen sc1
    buffer_store_dwordx4 v[240:243], v200, s[8:11], s30 offen sc1
attn_kernel_tw8e:
    s_nop 1
    v_mov_b32 v219, 0
    v_sub_f32 v189, 1.0, v166
    s_nop 1
    v_mfma_f32_32x32x16_bf16 v[240:255], v[234:237], v[214:217], 0
    v_mfma_f32_32x32x8bf16_1k v[240:255], v[238:239], v[218:219], v[240:255]
    s_lshl_b32 s29, s13, 1
    s_add_u32 s29, s29, 65
    s_mul_i32 s29, s29, 36864
    s_add_u32 s30, s29, 7340032
    s_nop 7
    s_nop 1
    v_mov_b32 v188, v250
    v_mov_b32 v187, v250
    s_nop 1
    v_permlane32_swap_b32 v188, v187
    s_nop 1
    v_add_f32 v188, 0x358637bd, v188
    v_rcp_f32 v188, v188
    s_nop 0
    v_mul_f32 v188, v188, v189
    v_mul_f32 v240, v240, v188
    v_mul_f32 v241, v241, v188
    v_mul_f32 v242, v242, v188
    v_mul_f32 v243, v243, v188
    v_mul_f32 v244, v244, v188
    v_mul_f32 v245, v245, v188
    v_mul_f32 v246, v246, v188
    v_mul_f32 v247, v247, v188
    v_mul_f32 v248, v248, v188
    v_mul_f32 v249, v249, v188
    v_cvt_pk_bf16_f32 v240, v240, v241
    v_cvt_pk_bf16_f32 v241, v242, v243
    v_cvt_pk_bf16_f32 v242, v244, v245
    v_cvt_pk_bf16_f32 v243, v246, v247
    v_cvt_pk_bf16_f32 v244, v248, v249
    s_nop 0
    v_permlane32_swap_b32 v240, v242
    v_permlane32_swap_b32 v241, v243
    s_cmp_eq_u32 s52, 0
    s_cbranch_scc1 attn_kernel_tw9s
    buffer_store_dword v244, v201, s[8:11], s30 offen
    buffer_store_dwordx4 v[240:243], v200, s[8:11], s30 offen
    s_branch attn_kernel_tw9e
attn_kernel_tw9s:
    buffer_store_dword v244, v201, s[8:11], s30 offen sc1
    buffer_store_dwordx4 v[240:243], v200, s[8:11], s30 offen sc1
attn_kernel_tw9e:
    s_cmp_eq_u32 s52, 0
    s_cbranch_scc1 attn_kernel_sgB10s
    s_lshl_b32 s28, s13, 8
    s_lshl_b32 s29, s12, 4
    s_add_u32 s28, s28, s29
    s_lshl_b32 s29, s15, 2
    s_add_u32 s28, s28, s29
    s_add_u32 s28, s28, 7258112
    s_waitcnt vmcnt(0)
    v_mov_b32 v186, 1
    v_mov_b32 v187, 2146435072
    v_mov_b32 v188, 0
    v_cmp_eq_u32 vcc, 0, v0
    s_nop 1
    v_cndmask_b32 v187, v187, v188, vcc
    buffer_store_dword v186, v187, s[8:11], s28 offen
    s_branch attn_kernel_sgB10e
attn_kernel_sgB10s:
    s_lshl_b32 s28, s13, 7
    s_add_u32 s28, s28, 7209984
    s_waitcnt vmcnt(0)
    v_mov_b32 v186, 1
    v_mov_b32 v187, 2146435072
    v_mov_b32 v188, 0
    v_cmp_eq_u32 vcc, 0, v0
    s_nop 1
    v_cndmask_b32 v187, v187, v188, vcc
    buffer_atomic_add v186, v187, s[8:11], s28 offen sc1
attn_kernel_sgB10e:
    s_mov_b32 s25, 11
    s_branch attn_kernel_loop
attn_kernel_hook4:
    v_and_b32 v194, 15, v2
    v_lshlrev_b32 v194, 7, v194
    v_add_u32 v194, 43008, v194
    v_mov_b32 v195, 36
    s_lshl_b32 s28, s13, 8
    s_add_u32 s28, s28, 49152
    v_lshlrev_b32 v196, 2, v2
    v_add_u32 v196, s28, v196
    s_lshl_b32 s28, s13, 7
    s_add_u32 s28, s28, 1024
    s_cmp_eq_u32 s52, 0
    s_cselect_b32 s29, 32, 1
    s_cselect_b64 vcc, -1, 0
    v_mov_b32 v198, s28
    v_cndmask_b32 v196, v196, v198, vcc
    v_mov_b32 v198, s29
    v_cmp_eq_u32 vcc, 0, v1
    s_nop 1
    v_cndmask_b32 v194, v194, v196, vcc
    v_cndmask_b32 v195, v195, v198, vcc
    s_mov_b32 s25, 0
    s_mov_b32 s24, 7208960
attn_kernel_pm11:
    buffer_load_dword v197, v194, s[8:11], s24 offen sc1
    s_waitcnt vmcnt(0)
    v_cmp_lt_u32 vcc, v197, v195
    s_nop 3
    s_cmp_eq_u64 vcc, 0
    s_cbranch_scc1 attn_kernel_pm11_ok
    s_add_u32 s25, s25, 1
    s_cmp_lt_u32 s25, 0x40000
    s_cbranch_scc0 attn_kernel_pm11_ok
    s_sleep 4
    s_branch attn_kernel_pm11
attn_kernel_pm11_ok:
    s_mul_i32 s46, s12, 82944
    s_add_u32 s46, s46, 5832704
    s_sub_u32 s46, s46, 77824
    s_and_b32 s26, s14, 1
    s_lshr_b32 s27, s14, 1
    s_mul_i32 s27, s27, 9
    s_lshl_b32 s28, s13, 1
    s_add_u32 s28, s28, s26
    s_add_u32 s28, s28, 64
    s_mul_i32 s28, s28, 36
    s_add_u32 s28, s28, s27
    s_lshl_b32 s53, s28, 10
    s_add_u32 s53, s53, 7340032
    s_add_u32 s28, s12, 8
    s_mul_i32 s28, s28, 36
    s_add_u32 s28, s28, s27
    s_mul_i32 s54, s28, 2304
    s_add_u32 s54, s54, 5832704
    buffer_load_dwordx4 v[150:153], v4, s[8:11], s53 offen
    buffer_load_dwordx4 v[156:159], v4, s[8:11], s54 offen
    buffer_load_dwordx4 v[160:163], v4, s[8:11], s54 offen offset:1024
    buffer_load_dwordx4 v[164:167], v175, s[8:11], s54 offen
    s_add_u32 s53, s53, 1024
    s_add_u32 s54, s54, 2304
    buffer_load_dwordx4 v[168:171], v4, s[8:11], s53 offen
    buffer_load_dwordx4 v[176:179], v4, s[8:11], s54 offen
    buffer_load_dwordx4 v[180:183], v4, s[8:11], s54 offen offset:1024
    buffer_load_dwordx4 v[184:187], v175, s[8:11], s54 offen
    s_add_u32 s53, s53, 1024
    s_add_u32 s54, s54, 2304
    buffer_load_dwordx4 v[188:191], v4, s[8:11], s53 offen
    buffer_load_dwordx4 v[192:195], v4, s[8:11], s54 offen
    buffer_load_dwordx4 v[196:199], v4, s[8:11], s54 offen offset:1024
    buffer_load_dwordx4 v[202:205], v175, s[8:11], s54 offen
    s_add_u32 s53, s53, 1024
    s_add_u32 s54, s54, 2304
attn_kernel_var0:
    v_mfma_f32_32x32x16_bf16 v[68:83], v[116:119], v[14:17], 0
    v_exp_f32 v52, v52
    ds_read_b128 v[130:133], v144 offset:2432
    v_exp_f32 v53, v53
    ds_read_b32 v134, v145 offset:2432
    v_exp_f32 v54, v54
    ds_read_b128 v[136:139], v146 offset:2432
    v_exp_f32 v55, v55
    v_mfma_f32_32x32x8bf16_1k v[68:83], v[120:121], v[18:19], v[68:83]
    v_exp_f32 v56, v56
    v_exp_f32 v57, v57
    v_exp_f32 v58, v58
    v_exp_f32 v59, v59
    v_smfmac_f32_32x32x32_bf16 v[36:51], v[140:143], v[108:115], v147
    v_exp_f32 v60, v60
    ds_read_b128 v[140:143], v174 offset:2432
    v_exp_f32 v61, v61
    v_exp_f32 v62, v62
    v_exp_f32 v63, v63
    v_smfmac_f32_32x32x32_bf16 v[20:35], v[122:125], v[52:59], v147
    v_exp_f32 v64, v64
    v_exp_f32 v65, v65
    v_exp_f32 v66, v66
    v_exp_f32 v67, v67
    s_waitcnt lgkmcnt(1)
    v_mfma_f32_32x32x16_bf16 v[84:99], v[130:133], v[8:11], 0
    v_exp_f32 v68, v68
    v_exp_f32 v69, v69
    v_exp_f32 v70, v70
    v_exp_f32 v71, v71
    v_mfma_f32_32x32x8bf16_1k v[84:99], v[134:135], v[12:13], v[84:99]
    v_exp_f32 v72, v72
    v_exp_f32 v73, v73
    s_waitcnt vmcnt(8)
    v_mfma_f32_32x32x16_bf16 v[208:223], v[156:159], v[150:153], 0
    v_exp_f32 v74, v74
    v_exp_f32 v75, v75
    v_smfmac_f32_32x32x32_bf16 v[20:35], v[126:129], v[60:67], v147
    v_exp_f32 v76, v76
    v_exp_f32 v77, v77
    v_mfma_f32_32x32x16_bf16 v[224:239], v[160:163], v[150:153], 0
    v_exp_f32 v78, v78
    v_exp_f32 v79, v79
    v_smfmac_f32_32x32x32_bf16 v[36:51], v[122:125], v[68:75], v147
    v_exp_f32 v80, v80
    v_exp_f32 v81, v81
    v_mfma_f32_32x32x16_bf16 v[240:255], v[164:167], v[150:153], 0
    v_exp_f32 v82, v82
    v_exp_f32 v83, v83
    buffer_load_dwordx4 v[150:153], v4, s[8:11], s53 offen
    buffer_load_dwordx4 v[156:159], v4, s[8:11], s54 offen
    buffer_load_dwordx4 v[160:163], v4, s[8:11], s54 offen offset:1024
    buffer_load_dwordx4 v[164:167], v175, s[8:11], s54 offen
    s_add_u32 s53, s53, 1024
    s_add_u32 s54, s54, 2304
    v_mfma_f32_32x32x16_bf16 v[100:115], v[130:133], v[14:17], 0
    v_exp_f32 v84, v84
    ds_read_b128 v[116:119], v144 offset:4864
    v_exp_f32 v85, v85
    ds_read_b32 v120, v145 offset:4864
    v_exp_f32 v86, v86
    ds_read_b128 v[122:125], v146 offset:4864
    v_exp_f32 v87, v87
    v_mfma_f32_32x32x8bf16_1k v[100:115], v[134:135], v[18:19], v[100:115]
    v_exp_f32 v88, v88
    v_exp_f32 v89, v89
    s_waitcnt vmcnt(8)
    v_mfma_f32_32x32x16_bf16 v[208:223], v[176:179], v[168:171], v[208:223]
    v_exp_f32 v90, v90
    v_exp_f32 v91, v91
    v_smfmac_f32_32x32x32_bf16 v[36:51], v[126:129], v[76:83], v147
    v_exp_f32 v92, v92
    ds_read_b128 v[126:129], v174 offset:4864
    v_exp_f32 v93, v93
    v_mfma_f32_32x32x16_bf16 v[224:239], v[180:183], v[168:171], v[224:239]
    v_exp_f32 v94, v94
    v_exp_f32 v95, v95
    v_smfmac_f32_32x32x32_bf16 v[20:35], v[136:139], v[84:91], v147
    v_exp_f32 v96, v96
    v_exp_f32 v97, v97
    v_mfma_f32_32x32x16_bf16 v[240:255], v[184:187], v[168:171], v[240:255]
    v_exp_f32 v98, v98
    v_exp_f32 v99, v99
    buffer_load_dwordx4 v[168:171], v4, s[8:11], s53 offen
    buffer_load_dwordx4 v[176:179], v4, s[8:11], s54 offen
    buffer_load_dwordx4 v[180:183], v4, s[8:11], s54 offen offset:1024
    buffer_load_dwordx4 v[184:187], v175, s[8:11], s54 offen
    s_add_u32 s53, s53, 1024
    s_add_u32 s54, s54, 2304
    s_waitcnt lgkmcnt(1)
    v_mfma_f32_32x32x16_bf16 v[52:67], v[116:119], v[8:11], 0
    v_exp_f32 v100, v100
    v_exp_f32 v101, v101
    v_exp_f32 v102, v102
    v_exp_f32 v103, v103
    v_mfma_f32_32x32x8bf16_1k v[52:67], v[120:121], v[12:13], v[52:67]
    v_exp_f32 v104, v104
    v_exp_f32 v105, v105
    s_waitcnt vmcnt(8)
    v_mfma_f32_32x32x16_bf16 v[208:223], v[192:195], v[188:191], v[208:223]
    v_exp_f32 v106, v106
    v_exp_f32 v107, v107
    v_smfmac_f32_32x32x32_bf16 v[20:35], v[140:143], v[92:99], v147
    v_exp_f32 v108, v108
    v_exp_f32 v109, v109
    v_mfma_f32_32x32x16_bf16 v[224:239], v[196:199], v[188:191], v[224:239]
    v_exp_f32 v110, v110
    v_exp_f32 v111, v111
    v_smfmac_f32_32x32x32_bf16 v[36:51], v[136:139], v[100:107], v147
    v_exp_f32 v112, v112
    v_exp_f32 v113, v113
    v_mfma_f32_32x32x16_bf16 v[240:255], v[202:205], v[188:191], v[240:255]
    v_exp_f32 v114, v114
    v_exp_f32 v115, v115
    buffer_load_dwordx4 v[188:191], v4, s[8:11], s53 offen
    buffer_load_dwordx4 v[192:195], v4, s[8:11], s54 offen
    buffer_load_dwordx4 v[196:199], v4, s[8:11], s54 offen offset:1024
    buffer_load_dwordx4 v[202:205], v175, s[8:11], s54 offen
    s_add_u32 s53, s53, 1024
    s_add_u32 s54, s54, 2304
    v_add_u32 v144, 4864, v144
    v_add_u32 v145, 4864, v145
    v_add_u32 v146, 4864, v146
    v_add_u32 v174, 4864, v174
attn_kernel_varA:
    v_mfma_f32_32x32x16_bf16 v[68:83], v[116:119], v[14:17], 0
    v_exp_f32 v52, v52
    ds_read_b128 v[130:133], v144 offset:2432
    v_exp_f32 v53, v53
    ds_read_b32 v134, v145 offset:2432
    v_exp_f32 v54, v54
    ds_read_b128 v[136:139], v146 offset:2432
    v_exp_f32 v55, v55
    v_mfma_f32_32x32x8bf16_1k v[68:83], v[120:121], v[18:19], v[68:83]
    v_exp_f32 v56, v56
    v_exp_f32 v57, v57
    v_exp_f32 v58, v58
    v_exp_f32 v59, v59
    v_smfmac_f32_32x32x32_bf16 v[36:51], v[140:143], v[108:115], v147
    v_exp_f32 v60, v60
    ds_read_b128 v[140:143], v174 offset:2432
    v_exp_f32 v61, v61
    v_exp_f32 v62, v62
    v_exp_f32 v63, v63
    v_smfmac_f32_32x32x32_bf16 v[20:35], v[122:125], v[52:59], v147
    v_exp_f32 v64, v64
    v_exp_f32 v65, v65
    v_exp_f32 v66, v66
    v_exp_f32 v67, v67
    s_waitcnt lgkmcnt(1)
    v_mfma_f32_32x32x16_bf16 v[84:99], v[130:133], v[8:11], 0
    v_exp_f32 v68, v68
    v_exp_f32 v69, v69
    v_exp_f32 v70, v70
    v_exp_f32 v71, v71
    v_mfma_f32_32x32x8bf16_1k v[84:99], v[134:135], v[12:13], v[84:99]
    v_exp_f32 v72, v72
    v_exp_f32 v73, v73
    s_waitcnt vmcnt(8)
    v_mfma_f32_32x32x16_bf16 v[208:223], v[156:159], v[150:153], v[208:223]
    v_exp_f32 v74, v74
    v_exp_f32 v75, v75
    v_smfmac_f32_32x32x32_bf16 v[20:35], v[126:129], v[60:67], v147
    v_exp_f32 v76, v76
    v_exp_f32 v77, v77
    v_mfma_f32_32x32x16_bf16 v[224:239], v[160:163], v[150:153], v[224:239]
    v_exp_f32 v78, v78
    v_exp_f32 v79, v79
    v_smfmac_f32_32x32x32_bf16 v[36:51], v[122:125], v[68:75], v147
    v_exp_f32 v80, v80
    v_exp_f32 v81, v81
    v_mfma_f32_32x32x16_bf16 v[240:255], v[164:167], v[150:153], v[240:255]
    v_exp_f32 v82, v82
    v_exp_f32 v83, v83
    buffer_load_dwordx4 v[150:153], v4, s[8:11], s53 offen
    buffer_load_dwordx4 v[156:159], v4, s[8:11], s54 offen
    buffer_load_dwordx4 v[160:163], v4, s[8:11], s54 offen offset:1024
    buffer_load_dwordx4 v[164:167], v175, s[8:11], s54 offen
    s_add_u32 s53, s53, 1024
    s_add_u32 s54, s54, 2304
    v_mfma_f32_32x32x16_bf16 v[100:115], v[130:133], v[14:17], 0
    v_exp_f32 v84, v84
    ds_read_b128 v[116:119], v144 offset:4864
    v_exp_f32 v85, v85
    ds_read_b32 v120, v145 offset:4864
    v_exp_f32 v86, v86
    ds_read_b128 v[122:125], v146 offset:4864
    v_exp_f32 v87, v87
    v_mfma_f32_32x32x8bf16_1k v[100:115], v[134:135], v[18:19], v[100:115]
    v_exp_f32 v88, v88
    v_exp_f32 v89, v89
    s_waitcnt vmcnt(8)
    v_mfma_f32_32x32x16_bf16 v[208:223], v[176:179], v[168:171], v[208:223]
    v_exp_f32 v90, v90
    v_exp_f32 v91, v91
    v_smfmac_f32_32x32x32_bf16 v[36:51], v[126:129], v[76:83], v147
    v_exp_f32 v92, v92
    ds_read_b128 v[126:129], v174 offset:4864
    v_exp_f32 v93, v93
    v_mfma_f32_32x32x16_bf16 v[224:239], v[180:183], v[168:171], v[224:239]
    v_exp_f32 v94, v94
    v_exp_f32 v95, v95
    v_smfmac_f32_32x32x32_bf16 v[20:35], v[136:139], v[84:91], v147
    v_exp_f32 v96, v96
    v_exp_f32 v97, v97
    v_mfma_f32_32x32x16_bf16 v[240:255], v[184:187], v[168:171], v[240:255]
    v_exp_f32 v98, v98
    v_exp_f32 v99, v99
    buffer_load_dwordx4 v[168:171], v4, s[8:11], s53 offen
    buffer_load_dwordx4 v[176:179], v4, s[8:11], s54 offen
    buffer_load_dwordx4 v[180:183], v4, s[8:11], s54 offen offset:1024
    buffer_load_dwordx4 v[184:187], v175, s[8:11], s54 offen
    s_add_u32 s53, s53, 1024
    s_add_u32 s54, s54, 2304
    s_waitcnt lgkmcnt(1)
    v_mfma_f32_32x32x16_bf16 v[52:67], v[116:119], v[8:11], 0
    v_exp_f32 v100, v100
    v_exp_f32 v101, v101
    v_exp_f32 v102, v102
    v_exp_f32 v103, v103
    v_mfma_f32_32x32x8bf16_1k v[52:67], v[120:121], v[12:13], v[52:67]
    v_exp_f32 v104, v104
    v_exp_f32 v105, v105
    s_waitcnt vmcnt(8)
    v_mfma_f32_32x32x16_bf16 v[208:223], v[192:195], v[188:191], v[208:223]
    v_exp_f32 v106, v106
    v_exp_f32 v107, v107
    v_smfmac_f32_32x32x32_bf16 v[20:35], v[140:143], v[92:99], v147
    v_exp_f32 v108, v108
    v_exp_f32 v109, v109
    v_mfma_f32_32x32x16_bf16 v[224:239], v[196:199], v[188:191], v[224:239]
    v_exp_f32 v110, v110
    v_exp_f32 v111, v111
    v_smfmac_f32_32x32x32_bf16 v[36:51], v[136:139], v[100:107], v147
    v_exp_f32 v112, v112
    v_exp_f32 v113, v113
    v_mfma_f32_32x32x16_bf16 v[240:255], v[202:205], v[188:191], v[240:255]
    v_exp_f32 v114, v114
    v_exp_f32 v115, v115
    buffer_load_dwordx4 v[188:191], v4, s[8:11], s53 offen
    buffer_load_dwordx4 v[192:195], v4, s[8:11], s54 offen
    buffer_load_dwordx4 v[196:199], v4, s[8:11], s54 offen offset:1024
    buffer_load_dwordx4 v[202:205], v175, s[8:11], s54 offen
    s_add_u32 s53, s53, 1024
    s_add_u32 s54, s54, 2304
    v_add_u32 v144, 4864, v144
    v_add_u32 v145, 4864, v145
    v_add_u32 v146, 4864, v146
    v_add_u32 v174, 4864, v174
attn_kernel_varB:
    v_mfma_f32_32x32x16_bf16 v[68:83], v[116:119], v[14:17], 0
    v_exp_f32 v52, v52
    ds_read_b128 v[130:133], v144 offset:2432
    v_exp_f32 v53, v53
    ds_read_b32 v134, v145 offset:2432
    v_exp_f32 v54, v54
    ds_read_b128 v[136:139], v146 offset:2432
    v_exp_f32 v55, v55
    v_mfma_f32_32x32x8bf16_1k v[68:83], v[120:121], v[18:19], v[68:83]
    v_exp_f32 v56, v56
    v_exp_f32 v57, v57
    v_exp_f32 v58, v58
    v_exp_f32 v59, v59
    v_smfmac_f32_32x32x32_bf16 v[36:51], v[140:143], v[108:115], v147
    v_exp_f32 v60, v60
    ds_read_b128 v[140:143], v174 offset:2432
    v_exp_f32 v61, v61
    v_exp_f32 v62, v62
    v_exp_f32 v63, v63
    v_smfmac_f32_32x32x32_bf16 v[20:35], v[122:125], v[52:59], v147
    v_exp_f32 v64, v64
    v_exp_f32 v65, v65
    v_exp_f32 v66, v66
    v_exp_f32 v67, v67
    s_waitcnt lgkmcnt(1)
    v_mfma_f32_32x32x16_bf16 v[84:99], v[130:133], v[8:11], 0
    v_exp_f32 v68, v68
    v_exp_f32 v69, v69
    v_exp_f32 v70, v70
    v_exp_f32 v71, v71
    v_mfma_f32_32x32x8bf16_1k v[84:99], v[134:135], v[12:13], v[84:99]
    v_exp_f32 v72, v72
    v_exp_f32 v73, v73
    s_waitcnt vmcnt(8)
    v_mfma_f32_32x32x16_bf16 v[208:223], v[156:159], v[150:153], v[208:223]
    v_exp_f32 v74, v74
    v_exp_f32 v75, v75
    v_smfmac_f32_32x32x32_bf16 v[20:35], v[126:129], v[60:67], v147
    v_exp_f32 v76, v76
    v_exp_f32 v77, v77
    v_mfma_f32_32x32x16_bf16 v[224:239], v[160:163], v[150:153], v[224:239]
    v_exp_f32 v78, v78
    v_exp_f32 v79, v79
    v_smfmac_f32_32x32x32_bf16 v[36:51], v[122:125], v[68:75], v147
    v_exp_f32 v80, v80
    v_exp_f32 v81, v81
    v_mfma_f32_32x32x16_bf16 v[240:255], v[164:167], v[150:153], v[240:255]
    v_exp_f32 v82, v82
    v_exp_f32 v83, v83
    v_mfma_f32_32x32x16_bf16 v[100:115], v[130:133], v[14:17], 0
    v_exp_f32 v84, v84
    ds_read_b128 v[116:119], v144 offset:4864
    v_exp_f32 v85, v85
    ds_read_b32 v120, v145 offset:4864
    v_exp_f32 v86, v86
    ds_read_b128 v[122:125], v146 offset:4864
    v_exp_f32 v87, v87
    v_mfma_f32_32x32x8bf16_1k v[100:115], v[134:135], v[18:19], v[100:115]
    v_exp_f32 v88, v88
    v_exp_f32 v89, v89
    s_waitcnt vmcnt(4)
    v_mfma_f32_32x32x16_bf16 v[208:223], v[176:179], v[168:171], v[208:223]
    v_exp_f32 v90, v90
    v_exp_f32 v91, v91
    v_smfmac_f32_32x32x32_bf16 v[36:51], v[126:129], v[76:83], v147
    v_exp_f32 v92, v92
    ds_read_b128 v[126:129], v174 offset:4864
    v_exp_f32 v93, v93
    v_mfma_f32_32x32x16_bf16 v[224:239], v[180:183], v[168:171], v[224:239]
    v_exp_f32 v94, v94
    v_exp_f32 v95, v95
    v_smfmac_f32_32x32x32_bf16 v[20:35], v[136:139], v[84:91], v147
    v_exp_f32 v96, v96
    v_exp_f32 v97, v97
    v_mfma_f32_32x32x16_bf16 v[240:255], v[184:187], v[168:171], v[240:255]
    v_exp_f32 v98, v98
    v_exp_f32 v99, v99
    s_waitcnt lgkmcnt(1)
    v_mfma_f32_32x32x16_bf16 v[52:67], v[116:119], v[8:11], 0
    v_exp_f32 v100, v100
    v_exp_f32 v101, v101
    v_exp_f32 v102, v102
    v_exp_f32 v103, v103
    v_mfma_f32_32x32x8bf16_1k v[52:67], v[120:121], v[12:13], v[52:67]
    v_exp_f32 v104, v104
    v_exp_f32 v105, v105
    s_waitcnt vmcnt(0)
    v_mfma_f32_32x32x16_bf16 v[208:223], v[192:195], v[188:191], v[208:223]
    v_exp_f32 v106, v106
    v_exp_f32 v107, v107
    v_smfmac_f32_32x32x32_bf16 v[20:35], v[140:143], v[92:99], v147
    v_exp_f32 v108, v108
    v_exp_f32 v109, v109
    v_mfma_f32_32x32x16_bf16 v[224:239], v[196:199], v[188:191], v[224:239]
    v_exp_f32 v110, v110
    v_exp_f32 v111, v111
    v_smfmac_f32_32x32x32_bf16 v[36:51], v[136:139], v[100:107], v147
    v_exp_f32 v112, v112
    v_exp_f32 v113, v113
    v_mfma_f32_32x32x16_bf16 v[240:255], v[202:205], v[188:191], v[240:255]
    v_exp_f32 v114, v114
    v_exp_f32 v115, v115
    v_add_u32 v144, 4864, v144
    v_add_u32 v145, 4864, v145
    v_add_u32 v146, 4864, v146
    v_add_u32 v174, 4864, v174
    s_cmp_eq_u32 s16, 0
    s_cbranch_scc1 attn_kernel_noWe
    v_mov_b32 v180, 163836
    v_mov_b32 v181, 1
    s_mov_b32 exec_hi, 0
    s_mov_b32 exec_lo, 1
    ds_add_u32 v180, v181
    s_mov_b64 exec, -1
attn_kernel_cl12:
    ds_read_b32 v181, v180
    s_waitcnt lgkmcnt(0)
    v_readfirstlane_b32 s29, v181
    s_nop 3
    s_cmp_ge_u32 s29, 4
    s_cbranch_scc1 attn_kernel_cl12_ok
    s_sleep 1
    s_branch attn_kernel_cl12
attn_kernel_cl12_ok:
    s_lshl_b32 s27, s15, 10
    s_add_u32 m0, s27, 77824
    s_add_u32 s26, m0, s46
    buffer_load_dwordx4 v4, s[8:11], s26 offen lds
    s_add_u32 m0, s27, 81920
    s_add_u32 s26, m0, s46
    buffer_load_dwordx4 v4, s[8:11], s26 offen lds
    s_add_u32 m0, s27, 86016
    s_add_u32 s26, m0, s46
    buffer_load_dwordx4 v4, s[8:11], s26 offen lds
    s_add_u32 m0, s27, 90112
    s_add_u32 s26, m0, s46
    buffer_load_dwordx4 v4, s[8:11], s26 offen lds
    s_add_u32 m0, s27, 94208
    s_add_u32 s26, m0, s46
    buffer_load_dwordx4 v4, s[8:11], s26 offen lds
    s_add_u32 m0, s27, 98304
    s_add_u32 s26, m0, s46
    buffer_load_dwordx4 v4, s[8:11], s26 offen lds
    s_add_u32 m0, s27, 102400
    s_add_u32 s26, m0, s46
    buffer_load_dwordx4 v4, s[8:11], s26 offen lds
    s_add_u32 m0, s27, 106496
    s_add_u32 s26, m0, s46
    buffer_load_dwordx4 v4, s[8:11], s26 offen lds
    s_add_u32 m0, s27, 110592
    s_add_u32 s26, m0, s46
    buffer_load_dwordx4 v4, s[8:11], s26 offen lds
    s_add_u32 m0, s27, 114688
    s_add_u32 s26, m0, s46
    buffer_load_dwordx4 v4, s[8:11], s26 offen lds
    s_add_u32 m0, s27, 118784
    s_add_u32 s26, m0, s46
    buffer_load_dwordx4 v4, s[8:11], s26 offen lds
    s_add_u32 m0, s27, 122880
    s_add_u32 s26, m0, s46
    buffer_load_dwordx4 v4, s[8:11], s26 offen lds
    s_add_u32 m0, s27, 126976
    s_add_u32 s26, m0, s46
    buffer_load_dwordx4 v4, s[8:11], s26 offen lds
    s_add_u32 m0, s27, 131072
    s_add_u32 s26, m0, s46
    buffer_load_dwordx4 v4, s[8:11], s26 offen lds
    s_mov_b32 m0, 135168
    s_add_u32 s26, m0, s46
    buffer_load_dwordx4 v4, s[8:11], s26 offen lds
attn_kernel_noWe:
    s_mov_b32 s25, s39
    s_cmp_lg_u32 s39, 0
    s_cbranch_scc1 attn_kernel_loop
attn_kernel_loopdone:
    s_nop 1
    v_smfmac_f32_32x32x32_bf16 v[36:51], v[140:143], v[108:115], v147
    s_waitcnt lgkmcnt(0)
    s_mul_i32 s26, s14, 3072
    s_add_u32 s26, s26, 0
    v_add_u32 v180, s26, v4
    s_xor_b32 s29, s14, 4
    s_mul_i32 s26, s29, 3072
    s_add_u32 s26, s26, 0
    v_add_u32 v181, s26, v4
    s_lshl_b32 s28, s13, 7
    s_add_u32 s45, s28, 5120
    s_nop 7
    v_min_f32 v182, v30, v46
    v_mov_b32 v183, 0x21800000
    v_cmp_nge_f32 vcc, v182, v183
    s_nop 3
    s_and_b32 s28, vcc_lo, vcc_lo
    s_cbranch_scc0 attn_kernel_done
    s_mul_i32 s28, s16, 77824
    s_add_u32 s28, s28, 77824
    v_subrev_u32 v144, s28, v144
    v_subrev_u32 v145, s28, v145
    v_subrev_u32 v146, s28, v146
    v_subrev_u32 v174, s28, v174
    v_mov_b32 v184, 0xff800000
    v_mov_b32 v185, 0xff800000
    v_mov_b32 v13, 0
    v_mov_b32 v19, 0
    v_mov_b32 v57, 0x3f80
    s_mov_b32 s25, 0
attn_kernel_fb:
    s_lshr_b32 s26, s25, 4
    s_lshl_b32 s27, s16, 1
    s_add_u32 s26, s26, s27
    s_add_u32 s26, s26, s19
    s_and_b32 s26, s26, 3
    s_mul_i32 s26, s26, 38912
    s_and_b32 s27, s25, 15
    s_mul_i32 s27, s27, 2432
    s_add_u32 s26, s26, s27
    buffer_load_dwordx4 v[52:55], v144, s[20:23], s26 offen
    buffer_load_dword v56, v145, s[20:23], s26 offen
    s_waitcnt vmcnt(0)
    v_mfma_f32_32x32x16_bf16 v[68:83], v[52:55], v[8:11], 0
    v_mfma_f32_32x32x8bf16_1k v[68:83], v[56:57], v[12:13], v[68:83]
    v_mfma_f32_32x32x16_bf16 v[84:99], v[52:55], v[14:17], 0
    v_mfma_f32_32x32x8bf16_1k v[84:99], v[56:57], v[18:19], v[84:99]
    s_nop 7
    s_nop 7
    v_max3_f32 v184, v68, v69, v184
    v_max3_f32 v184, v70, v71, v184
    v_max3_f32 v184, v72, v73, v184
    v_max3_f32 v184, v74, v75, v184
    v_max3_f32 v184, v76, v77, v184
    v_max3_f32 v184, v78, v79, v184
    v_max3_f32 v184, v80, v81, v184
    v_max3_f32 v184, v82, v83, v184
    v_max3_f32 v185, v84, v85, v185
    v_max3_f32 v185, v86, v87, v185
    v_max3_f32 v185, v88, v89, v185
    v_max3_f32 v185, v90, v91, v185
    v_max3_f32 v185, v92, v93, v185
    v_max3_f32 v185, v94, v95, v185
    v_max3_f32 v185, v96, v97, v185
    v_max3_f32 v185, v98, v99, v185
    s_add_u32 s25, s25, 1
    s_cmp_lt_u32 s25, 32
    s_cbranch_scc1 attn_kernel_fb
    v_mov_b32 v183, v184
    s_nop 1
    v_permlane32_swap_b32 v184, v183
    s_nop 1
    v_max_f32 v182, v184, v183
    v_sub_f32 v182, 0, v182
    v_cvt_pk_bf16_f32 v183, v182, 0
    v_lshlrev_b32 v148, 16, v183
    v_cmp_eq_u32 vcc, 0, v1
    s_nop 1
    v_cndmask_b32 v13, 0, v183, vcc
    v_mov_b32 v183, v185
    s_nop 1
    v_permlane32_swap_b32 v185, v183
    s_nop 1
    v_max_f32 v182, v185, v183
    v_sub_f32 v182, 0, v182
    v_cvt_pk_bf16_f32 v183, v182, 0
    v_lshlrev_b32 v149, 16, v183
    v_cmp_eq_u32 vcc, 0, v1
    s_nop 1
    v_cndmask_b32 v19, 0, v183, vcc
    v_mov_b32 v20, 0
    v_mov_b32 v21, 0
    v_mov_b32 v22, 0
    v_mov_b32 v23, 0
    v_mov_b32 v24, 0
    v_mov_b32 v25, 0
    v_mov_b32 v26, 0
    v_mov_b32 v27, 0
    v_mov_b32 v28, 0
    v_mov_b32 v29, 0
    v_mov_b32 v30, 0
    v_mov_b32 v31, 0
    v_mov_b32 v32, 0
    v_mov_b32 v33, 0
    v_mov_b32 v34, 0
    v_mov_b32 v35, 0
    v_mov_b32 v36, 0
    v_mov_b32 v37, 0
    v_mov_b32 v38, 0
    v_mov_b32 v39, 0
    v_mov_b32 v40, 0
    v_mov_b32 v41, 0
    v_mov_b32 v42, 0
    v_mov_b32 v43, 0
    v_mov_b32 v44, 0
    v_mov_b32 v45, 0
    v_mov_b32 v46, 0
    v_mov_b32 v47, 0
    v_mov_b32 v48, 0
    v_mov_b32 v49, 0
    v_mov_b32 v50, 0
    v_mov_b32 v51, 0
    s_mov_b32 s25, 0
attn_kernel_fb2:
    s_lshr_b32 s26, s25, 4
    s_lshl_b32 s27, s16, 1
    s_add_u32 s26, s26, s27
    s_add_u32 s26, s26, s19
    s_and_b32 s26, s26, 3
    s_mul_i32 s26, s26, 38912
    s_and_b32 s27, s25, 15
    s_mul_i32 s27, s27, 2432
    s_add_u32 s26, s26, s27
    buffer_load_dwordx4 v[52:55], v144, s[20:23], s26 offen
    buffer_load_dword v56, v145, s[20:23], s26 offen
    buffer_load_dwordx4 v[58:61], v146, s[20:23], s26 offen
    buffer_load_dwordx4 v[62:65], v174, s[20:23], s26 offen
    s_waitcnt vmcnt(0)
    v_mfma_f32_32x32x16_bf16 v[68:83], v[52:55], v[8:11], 0
    v_mfma_f32_32x32x8bf16_1k v[68:83], v[56:57], v[12:13], v[68:83]
    v_mfma_f32_32x32x16_bf16 v[84:99], v[52:55], v[14:17], 0
    v_mfma_f32_32x32x8bf16_1k v[84:99], v[56:57], v[18:19], v[84:99]
    s_nop 7
    s_nop 7
    v_exp_f32 v68, v68
    v_exp_f32 v69, v69
    v_exp_f32 v70, v70
    v_exp_f32 v71, v71
    v_exp_f32 v72, v72
    v_exp_f32 v73, v73
    v_exp_f32 v74, v74
    v_exp_f32 v75, v75
    v_exp_f32 v76, v76
    v_exp_f32 v77, v77
    v_exp_f32 v78, v78
    v_exp_f32 v79, v79
    v_exp_f32 v80, v80
    v_exp_f32 v81, v81
    v_exp_f32 v82, v82
    v_exp_f32 v83, v83
    v_exp_f32 v84, v84
    v_exp_f32 v85, v85
    v_exp_f32 v86, v86
    v_exp_f32 v87, v87
    v_exp_f32 v88, v88
    v_exp_f32 v89, v89
    v_exp_f32 v90, v90
    v_exp_f32 v91, v91
    v_exp_f32 v92, v92
    v_exp_f32 v93, v93
    v_exp_f32 v94, v94
    v_exp_f32 v95, v95
    v_exp_f32 v96, v96
    v_exp_f32 v97, v97
    v_exp_f32 v98, v98
    v_exp_f32 v99, v99
    s_nop 1
    v_smfmac_f32_32x32x32_bf16 v[20:35], v[58:61], v[68:75], v147
    v_smfmac_f32_32x32x32_bf16 v[20:35], v[62:65], v[76:83], v147
    v_smfmac_f32_32x32x32_bf16 v[36:51], v[58:61], v[84:91], v147
    v_smfmac_f32_32x32x32_bf16 v[36:51], v[62:65], v[92:99], v147
    s_nop 7
    s_nop 7
    s_add_u32 s25, s25, 1
    s_cmp_lt_u32 s25, 32
    s_cbranch_scc1 attn_kernel_fb2
attn_kernel_done:
    v_mov_b32 v31, v148
    v_mov_b32 v47, v149
    s_mov_b32 s40, s6
    s_and_b32 s41, s7, 0xffff
    s_mov_b32 s42, 2359296
    s_mov_b32 s43, 0x20000
    s_setprio 0
    s_barrier
    s_lshl_b32 s27, s14, 10
    s_add_u32 m0, s27, 136192
    s_add_u32 s26, m0, s46
    buffer_load_dwordx4 v4, s[8:11], s26 offen lds
    s_add_u32 m0, s27, 144384
    s_add_u32 s26, m0, s46
    buffer_load_dwordx4 v4, s[8:11], s26 offen lds
    s_add_u32 m0, s27, 152576
    s_add_u32 s26, m0, s46
    buffer_load_dwordx4 v4, s[8:11], s26 offen lds
    s_cmp_eq_u32 s16, 0
    s_cbranch_scc1 attn_kernel_kh0
    ds_write_b128 v180, v[20:23] offset:0
    ds_write_b128 v180, v[24:27] offset:1024
    ds_write_b128 v180, v[28:31] offset:2048
    v_mov_b32 v20, v36
    v_mov_b32 v21, v37
    v_mov_b32 v22, v38
    v_mov_b32 v23, v39
    v_mov_b32 v24, v40
    v_mov_b32 v25, v41
    v_mov_b32 v26, v42
    v_mov_b32 v27, v43
    v_mov_b32 v28, v44
    v_mov_b32 v29, v45
    v_mov_b32 v30, v46
    v_mov_b32 v31, v47
    s_branch attn_kernel_sent
attn_kernel_kh0:
    ds_write_b128 v180, v[36:39] offset:0
    ds_write_b128 v180, v[40:43] offset:1024
    ds_write_b128 v180, v[44:47] offset:2048
attn_kernel_sent:
    s_waitcnt lgkmcnt(0)
    s_barrier
    ds_read_b128 v[36:39], v181 offset:0
    ds_read_b128 v[40:43], v181 offset:1024
    ds_read_b128 v[44:47], v181 offset:2048
    s_waitcnt lgkmcnt(0)
    v_min_f32 v184, v31, v47
    v_sub_f32 v185, v184, v31
    v_sub_f32 v186, v184, v47
    v_exp_f32 v185, v185
    v_exp_f32 v186, v186
    s_nop 0
    v_mul_f32 v20, v20, v185
    v_mul_f32 v21, v21, v185
    v_mul_f32 v22, v22, v185
    v_mul_f32 v23, v23, v185
    v_mul_f32 v24, v24, v185
    v_mul_f32 v25, v25, v185
    v_mul_f32 v26, v26, v185
    v_mul_f32 v27, v27, v185
    v_mul_f32 v28, v28, v185
    v_mul_f32 v29, v29, v185
    v_mul_f32 v30, v30, v185
    v_fmac_f32 v20, v36, v186
    v_fmac_f32 v21, v37, v186
    v_fmac_f32 v22, v38, v186
    v_fmac_f32 v23, v39, v186
    v_fmac_f32 v24, v40, v186
    v_fmac_f32 v25, v41, v186
    v_fmac_f32 v26, v42, v186
    v_fmac_f32 v27, v43, v186
    v_fmac_f32 v28, v44, v186
    v_fmac_f32 v29, v45, v186
    v_fmac_f32 v30, v46, v186
    v_mov_b32 v188, v30
    v_mov_b32 v187, v30
    s_nop 1
    v_permlane32_swap_b32 v188, v187
    s_nop 1
    v_rcp_f32 v188, v188
    s_nop 0
    v_mul_f32 v188, v188, v155
    v_mul_f32 v20, v20, v188
    v_mul_f32 v21, v21, v188
    v_mul_f32 v22, v22, v188
    v_mul_f32 v23, v23, v188
    v_mul_f32 v24, v24, v188
    v_mul_f32 v25, v25, v188
    v_mul_f32 v26, v26, v188
    v_mul_f32 v27, v27, v188
    v_mul_f32 v28, v28, v188
    v_mul_f32 v29, v29, v188
    v_cvt_pk_bf16_f32 v20, v20, v21
    v_cvt_pk_bf16_f32 v21, v22, v23
    v_cvt_pk_bf16_f32 v22, v24, v25
    v_cvt_pk_bf16_f32 v23, v26, v27
    v_cvt_pk_bf16_f32 v24, v28, v29
    s_nop 0
    v_permlane32_swap_b32 v20, v22
    v_permlane32_swap_b32 v21, v23
    s_cmp_eq_u32 s52, 0
    s_cbranch_scc1 attn_kernel_slowst
    buffer_store_dword v24, v201, s[8:11], s37 offen
    buffer_store_dwordx4 v[20:23], v200, s[8:11], s37 offen
    s_branch attn_kernel_stdone
attn_kernel_slowst:
    buffer_store_dword v24, v201, s[8:11], s37 offen sc1
    buffer_store_dwordx4 v[20:23], v200, s[8:11], s37 offen sc1
attn_kernel_stdone:
    s_cmp_eq_u32 s52, 0
    s_cbranch_scc1 attn_kernel_sgA13s
    s_lshl_b32 s28, s13, 8
    s_lshl_b32 s29, s12, 5
    s_add_u32 s28, s28, s29
    s_lshl_b32 s29, s14, 2
    s_add_u32 s28, s28, s29
    s_add_u32 s28, s28, 7222272
    s_waitcnt vmcnt(0)
    v_mov_b32 v186, 1
    v_mov_b32 v187, 2146435072
    v_mov_b32 v188, 0
    v_cmp_eq_u32 vcc, 0, v0
    s_nop 1
    v_cndmask_b32 v187, v187, v188, vcc
    buffer_store_dword v186, v187, s[8:11], s28 offen
    s_branch attn_kernel_sgA13e
attn_kernel_sgA13s:
    s_add_u32 s28, s45, 7208960
    s_waitcnt vmcnt(0)
    v_mov_b32 v186, 1
    v_mov_b32 v187, 2146435072
    v_mov_b32 v188, 0
    v_cmp_eq_u32 vcc, 0, v0
    s_nop 1
    v_cndmask_b32 v187, v187, v188, vcc
    buffer_atomic_add v186, v187, s[8:11], s28 offen sc1
attn_kernel_sgA13e:
    s_cmp_eq_u32 s14, 0
    s_cbranch_scc0 attn_kernel_nopA
    s_cmp_eq_u32 s52, 0
    s_cbranch_scc1 attn_kernel_spA14s
    s_lshl_b32 s28, s13, 8
    s_add_u32 s28, s28, 13312
    v_lshlrev_b32 v194, 2, v0
    v_add_u32 v194, s28, v194
    v_mov_b32 v195, 1
    s_mov_b32 s25, 0
    s_mov_b32 s24, 7208960
attn_kernel_pm15:
    buffer_load_dword v197, v194, s[8:11], s24 offen sc1
    s_waitcnt vmcnt(0)
    v_cmp_lt_u32 vcc, v197, v195
    s_nop 3
    s_cmp_eq_u64 vcc, 0
    s_cbranch_scc1 attn_kernel_pm15_ok
    s_add_u32 s25, s25, 1
    s_cmp_lt_u32 s25, 0x40000
    s_cbranch_scc0 attn_kernel_pm15_ok
    s_sleep 1
    s_branch attn_kernel_pm15
attn_kernel_pm15_ok:
    s_branch attn_kernel_spA14e
attn_kernel_spA14s:
    v_mov_b32 v194, s45
    v_mov_b32 v195, 64
    s_mov_b32 s25, 0
    s_mov_b32 s24, 7208960
attn_kernel_pm16:
    buffer_load_dword v197, v194, s[8:11], s24 offen sc1
    s_waitcnt vmcnt(0)
    v_cmp_lt_u32 vcc, v197, v195
    s_nop 3
    s_and_b32 s26, vcc_lo, 1
    s_cbranch_scc0 attn_kernel_pm16_ok
    s_add_u32 s25, s25, 1
    s_cmp_lt_u32 s25, 0x40000
    s_cbranch_scc0 attn_kernel_pm16_ok
    s_sleep 2
    s_branch attn_kernel_pm16
attn_kernel_pm16_ok:
attn_kernel_spA14e:
attn_kernel_nopA:
    s_waitcnt vmcnt(0)
    s_barrier
    s_and_b32 s26, s14, 1
    s_lshr_b32 s27, s14, 1
    s_mul_i32 s27, s27, 9
    s_lshl_b32 s28, s13, 1
    s_add_u32 s28, s28, s26
    s_mul_i32 s28, s28, 36
    s_add_u32 s28, s28, s27
    s_lshl_b32 s28, s28, 10
    s_add_u32 s28, s28, 7340032
    s_mul_i32 s27, s27, 2304
    s_add_u32 s27, s27, 77824
    v_add_u32 v196, s27, v4
    v_add_u32 v197, s27, v175
    s_cmp_eq_u32 s52, 0
    s_cbranch_scc1 attn_kernel_tw17s
    buffer_load_dwordx4 v[160:163], v4, s[8:11], s28 offen offset:0
    buffer_load_dwordx4 v[164:167], v4, s[8:11], s28 offen offset:1024
    buffer_load_dwordx4 v[168:171], v4, s[8:11], s28 offen offset:2048
    buffer_load_dwordx4 v[172:175], v4, s[8:11], s28 offen offset:3072
    s_add_u32 s28, s28, 4096
    buffer_load_dwordx4 v[176:179], v4, s[8:11], s28 offen offset:0
    buffer_load_dwordx4 v[180:183], v4, s[8:11], s28 offen offset:1024
    buffer_load_dwordx4 v[184:187], v4, s[8:11], s28 offen offset:2048
    buffer_load_dwordx4 v[188:191], v4, s[8:11], s28 offen offset:3072
    s_add_u32 s28, s28, 4096
    buffer_load_dwordx4 v[192:195], v4, s[8:11], s28 offen offset:0
    s_branch attn_kernel_tw17e
attn_kernel_tw17s:
    buffer_load_dwordx4 v[160:163], v4, s[8:11], s28 offen offset:0 sc1
    buffer_load_dwordx4 v[164:167], v4, s[8:11], s28 offen offset:1024 sc1
    buffer_load_dwordx4 v[168:171], v4, s[8:11], s28 offen offset:2048 sc1
    buffer_load_dwordx4 v[172:175], v4, s[8:11], s28 offen offset:3072 sc1
    s_add_u32 s28, s28, 4096
    buffer_load_dwordx4 v[176:179], v4, s[8:11], s28 offen offset:0 sc1
    buffer_load_dwordx4 v[180:183], v4, s[8:11], s28 offen offset:1024 sc1
    buffer_load_dwordx4 v[184:187], v4, s[8:11], s28 offen offset:2048 sc1
    buffer_load_dwordx4 v[188:191], v4, s[8:11], s28 offen offset:3072 sc1
    s_add_u32 s28, s28, 4096
    buffer_load_dwordx4 v[192:195], v4, s[8:11], s28 offen offset:0 sc1
attn_kernel_tw17e:
    ds_read_b128 v[52:55], v196 offset:0
    ds_read_b128 v[56:59], v196 offset:1024
    ds_read_b128 v[60:63], v197 offset:0
    ds_read_b128 v[64:67], v196 offset:2304
    ds_read_b128 v[68:71], v196 offset:3328
    ds_read_b128 v[72:75], v197 offset:2304
    ds_read_b128 v[76:79], v196 offset:4608
    ds_read_b128 v[80:83], v196 offset:5632
    ds_read_b128 v[84:87], v197 offset:4608
    ds_read_b128 v[88:91], v196 offset:6912
    ds_read_b128 v[92:95], v196 offset:7936
    ds_read_b128 v[96:99], v197 offset:6912
    ds_read_b128 v[100:103], v196 offset:9216
    ds_read_b128 v[104:107], v196 offset:10240
    ds_read_b128 v[108:111], v197 offset:9216
    s_waitcnt vmcnt(8) lgkmcnt(12)
    v_mfma_f32_32x32x16_bf16 v[208:223], v[52:55], v[160:163], v[208:223]
    v_mfma_f32_32x32x16_bf16 v[224:239], v[56:59], v[160:163], v[224:239]
    v_mfma_f32_32x32x16_bf16 v[240:255], v[60:63], v[160:163], v[240:255]
    ds_read_b128 v[112:115], v196 offset:11520
    ds_read_b128 v[116:119], v196 offset:12544
    ds_read_b128 v[120:123], v197 offset:11520
    s_waitcnt vmcnt(7) lgkmcnt(12)
    v_mfma_f32_32x32x16_bf16 v[208:223], v[64:67], v[164:167], v[208:223]
    v_mfma_f32_32x32x16_bf16 v[224:239], v[68:71], v[164:167], v[224:239]
    v_mfma_f32_32x32x16_bf16 v[240:255], v[72:75], v[164:167], v[240:255]
    ds_read_b128 v[124:127], v196 offset:13824
    ds_read_b128 v[128:131], v196 offset:14848
    ds_read_b128 v[132:135], v197 offset:13824
    s_waitcnt vmcnt(6) lgkmcnt(12)
    v_mfma_f32_32x32x16_bf16 v[208:223], v[76:79], v[168:171], v[208:223]
    v_mfma_f32_32x32x16_bf16 v[224:239], v[80:83], v[168:171], v[224:239]
    v_mfma_f32_32x32x16_bf16 v[240:255], v[84:87], v[168:171], v[240:255]
    ds_read_b128 v[136:139], v196 offset:16128
    ds_read_b128 v[140:143], v196 offset:17152
    ds_read_b128 v[144:147], v197 offset:16128
    s_waitcnt vmcnt(5) lgkmcnt(12)
    v_mfma_f32_32x32x16_bf16 v[208:223], v[88:91], v[172:175], v[208:223]
    v_mfma_f32_32x32x16_bf16 v[224:239], v[92:95], v[172:175], v[224:239]
    v_mfma_f32_32x32x16_bf16 v[240:255], v[96:99], v[172:175], v[240:255]
    ds_read_b128 v[148:151], v196 offset:18432
    ds_read_b128 v[152:155], v196 offset:19456
    ds_read_b128 v[156:159], v197 offset:18432
    s_waitcnt vmcnt(4) lgkmcnt(12)
    v_mfma_f32_32x32x16_bf16 v[208:223], v[100:103], v[176:179], v[208:223]
    v_mfma_f32_32x32x16_bf16 v[224:239], v[104:107], v[176:179], v[224:239]
    v_mfma_f32_32x32x16_bf16 v[240:255], v[108:111], v[176:179], v[240:255]
    s_waitcnt vmcnt(3) lgkmcnt(9)
    v_mfma_f32_32x32x16_bf16 v[208:223], v[112:115], v[180:183], v[208:223]
    v_mfma_f32_32x32x16_bf16 v[224:239], v[116:119], v[180:183], v[224:239]
    v_mfma_f32_32x32x16_bf16 v[240:255], v[120:123], v[180:183], v[240:255]
    s_waitcnt vmcnt(2) lgkmcnt(6)
    v_mfma_f32_32x32x16_bf16 v[208:223], v[124:127], v[184:187], v[208:223]
    v_mfma_f32_32x32x16_bf16 v[224:239], v[128:131], v[184:187], v[224:239]
    v_mfma_f32_32x32x16_bf16 v[240:255], v[132:135], v[184:187], v[240:255]
    s_waitcnt vmcnt(1) lgkmcnt(3)
    v_mfma_f32_32x32x16_bf16 v[208:223], v[136:139], v[188:191], v[208:223]
    v_mfma_f32_32x32x16_bf16 v[224:239], v[140:143], v[188:191], v[224:239]
    v_mfma_f32_32x32x16_bf16 v[240:255], v[144:147], v[188:191], v[240:255]
    s_waitcnt vmcnt(0) lgkmcnt(0)
    v_mfma_f32_32x32x16_bf16 v[208:223], v[148:151], v[192:195], v[208:223]
    v_mfma_f32_32x32x16_bf16 v[224:239], v[152:155], v[192:195], v[224:239]
    v_mfma_f32_32x32x16_bf16 v[240:255], v[156:159], v[192:195], v[240:255]
    s_and_b32 s26, s14, 1
    s_lshr_b32 s27, s14, 1
    s_lshl_b32 s28, s26, 2
    s_add_u32 s28, s28, s27
    s_mul_i32 s28, s28, 9216
    s_add_u32 s28, s28, 0
    v_add_u32 v196, s28, v4
    s_mul_i32 s28, s26, 36864
    s_lshl_b32 s29, s27, 11
    s_add_u32 s28, s28, s29
    s_add_u32 s28, s28, 0
    v_add_u32 v197, s28, v4
    s_mul_i32 s28, s26, 36864
    s_add_u32 s28, s28, 8192
    v_add_u32 v198, s28, v4
    s_lshl_b32 s28, s13, 1
    s_add_u32 s28, s28, s26
    s_mul_i32 s28, s28, 36864
    s_mul_i32 s29, s12, 144
    s_add_u32 s28, s28, s29
    s_lshl_b32 s29, s27, 5
    s_add_u32 s46, s28, s29
    v_mul_u32_u24 v199, 1152, v2
    v_lshlrev_b32 v200, 4, v1
    v_add_u32 v200, v199, v200
    v_lshlrev_b32 v201, 3, v1
    v_add_u32 v201, v199, v201
    s_nop 3
    ds_write_b128 v196, v[208:211] offset:0
    ds_write_b128 v196, v[212:215] offset:1024
    ds_write_b128 v196, v[216:219] offset:2048
    ds_write_b128 v196, v[220:223] offset:3072
    ds_write_b128 v196, v[224:227] offset:4096
    ds_write_b128 v196, v[228:231] offset:5120
    ds_write_b128 v196, v[232:235] offset:6144
    ds_write_b128 v196, v[236:239] offset:7168
    ds_write_b128 v196, v[240:243] offset:8192
    s_waitcnt lgkmcnt(0)
    s_barrier
    ds_read_b128 v[52:55], v197 offset:0
    ds_read_b128 v[56:59], v197 offset:1024
    ds_read_b128 v[60:63], v197 offset:9216
    ds_read_b128 v[64:67], v197 offset:10240
    ds_read_b128 v[68:71], v197 offset:18432
    ds_read_b128 v[72:75], v197 offset:19456
    ds_read_b128 v[76:79], v197 offset:27648
    ds_read_b128 v[80:83], v197 offset:28672
    s_cmp_eq_u32 s27, 0
    s_cbranch_scc0 attn_kernel_noc8
    ds_read_b128 v[84:87], v198 offset:0
    ds_read_b128 v[88:91], v198 offset:9216
    ds_read_b128 v[92:95], v198 offset:18432
    ds_read_b128 v[96:99], v198 offset:27648
    s_waitcnt lgkmcnt(0)
    v_add_f32 v84, v84, v88
    v_add_f32 v92, v92, v96
    v_add_f32 v85, v85, v89
    v_add_f32 v93, v93, v97
    v_add_f32 v86, v86, v90
    v_add_f32 v94, v94, v98
    v_add_f32 v87, v87, v91
    v_add_f32 v95, v95, v99
    v_add_f32 v84, v84, v92
    v_add_f32 v85, v85, v93
    v_add_f32 v86, v86, v94
    v_add_f32 v87, v87, v95
    v_cvt_pk_bf16_f32 v84, v84, v85
    v_cvt_pk_bf16_f32 v85, v86, v87
    buffer_store_dwordx2 v[84:85], v201, s[40:43], s46 offen offset:128
attn_kernel_noc8:
    s_waitcnt lgkmcnt(0)
    v_add_f32 v52, v52, v60
    v_add_f32 v68, v68, v76
    v_add_f32 v53, v53, v61
    v_add_f32 v69, v69, v77
    v_add_f32 v54, v54, v62
    v_add_f32 v70, v70, v78
    v_add_f32 v55, v55, v63
    v_add_f32 v71, v71, v79
    v_add_f32 v56, v56, v64
    v_add_f32 v72, v72, v80
    v_add_f32 v57, v57, v65
    v_add_f32 v73, v73, v81
    v_add_f32 v58, v58, v66
    v_add_f32 v74, v74, v82
    v_add_f32 v59, v59, v67
    v_add_f32 v75, v75, v83
    v_add_f32 v52, v52, v68
    v_add_f32 v53, v53, v69
    v_add_f32 v54, v54, v70
    v_add_f32 v55, v55, v71
    v_add_f32 v56, v56, v72
    v_add_f32 v57, v57, v73
    v_add_f32 v58, v58, v74
    v_add_f32 v59, v59, v75
    v_cvt_pk_bf16_f32 v52, v52, v53
    v_cvt_pk_bf16_f32 v53, v54, v55
    v_cvt_pk_bf16_f32 v54, v56, v57
    v_cvt_pk_bf16_f32 v55, v58, v59
    s_nop 1
    v_permlane32_swap_b32 v52, v54
    v_permlane32_swap_b32 v53, v55
    buffer_store_dwordx4 v[52:55], v200, s[40:43], s46 offen
attn_kernel_end:
    s_endpgm
.section .rodata,"a"
.p2align 6
.amdhsa_kernel gated_mix__grouped_kv_mqa__linear_attn_block__prompt_kernel
  .amdhsa_next_free_vgpr 256
  .amdhsa_next_free_sgpr 102
  .amdhsa_accum_offset 256
  .amdhsa_group_segment_fixed_size 0
  .amdhsa_kernarg_size 96
  .amdhsa_user_sgpr_count 2
  .amdhsa_user_sgpr_kernarg_segment_ptr 1
  .amdhsa_system_sgpr_workgroup_id_x 1
  .amdhsa_float_denorm_mode_32 3
.end_amdhsa_kernel
.text
.fill 256, 4, 0xBF800000
```
